```python
import torch

def _softmax(x, axis=-1):
    return torch.softmax(x, dim=axis)

def _gelu(x):
    return torch.nn.functional.gelu(x, approximate='tanh')

def _silu(x):
    return torch.nn.functional.silu(x)

def _sigmoid(x):
    return torch.sigmoid(x)

def _layernorm(x, axis=-1, eps=1e-05):
    m = x.mean(dim=axis, keepdim=True)
    v = x.var(dim=axis, keepdim=True, unbiased=False)
    return (x - m) / torch.sqrt(v + eps)

def _scatter_add(tgt, idx, src, axis=0):
    return tgt.clone().index_add_(axis, idx, src)

def _segment_sum(src, seg, n):
    out = torch.zeros((n,) + src.shape[1:], dtype=src.dtype)
    return out.index_add_(0, seg, src)

def _pad(x, pw):
    flat = tuple((v for pair in reversed(pw) for v in pair))
    return torch.nn.functional.pad(x, flat)
kernel_name = 'standalone__tree_speculative_verify_tree_attention_over_candidate_token_tree__sampling'

def setup_inputs():

    _w = lambda a: (lambda t: t.to(torch.bfloat16) if t.is_floating_point() else t)(torch.as_tensor(a))
    B, Hq, Hkv, T, C, D = (8, 32, 8, 1, 8192, 128)
    tree_mask = torch.zeros((B, T, T), dtype=float)
    for b in range(B):
        parent = torch.zeros(T, dtype=torch.int64)
        for i in range(1, T):
            parent[i] = int(torch.randint(0, i, (1,)).item())
        for i in range(T):
            j = i
            tree_mask[b, i, j] = 1.0
            while j > 0:
                j = parent[j]
                tree_mask[b, i, j] = 1.0
    return {'q': _w((lambda *s: torch.randn(*s, dtype=torch.bfloat16) * 0.8)(B, Hq, T, D)), 'k_cache': _w((lambda *s: torch.randn(*s, dtype=torch.bfloat16) * 0.8)(B, Hkv, C, D)), 'v_cache': _w((lambda *s: torch.randn(*s, dtype=torch.bfloat16) * 0.05)(B, Hkv, C, D)), 'k_tree': _w((lambda *s: torch.randn(*s, dtype=torch.bfloat16) * 0.8)(B, Hkv, T, D)), 'v_tree': _w((lambda *s: torch.randn(*s, dtype=torch.bfloat16) * 0.05)(B, Hkv, T, D)), 'tree_mask': _w(tree_mask)}

def reference(q, k_cache, v_cache, k_tree, v_tree, tree_mask):
    B, Hq, T, D = q.shape
    Hkv, C = (k_cache.shape[1], k_cache.shape[2])
    rep = Hq // Hkv
    kc = (lambda x, n, axis: torch.repeat_interleave(x, n, dim=axis))(k_cache, rep, axis=1)
    vc = (lambda x, n, axis: torch.repeat_interleave(x, n, dim=axis))(v_cache, rep, axis=1)
    kt = (lambda x, n, axis: torch.repeat_interleave(x, n, dim=axis))(k_tree, rep, axis=1)
    vt = (lambda x, n, axis: torch.repeat_interleave(x, n, dim=axis))(v_tree, rep, axis=1)
    k = torch.concatenate([kc, kt], axis=2)
    v = torch.concatenate([vc, vt], axis=2)
    scale = D ** (-0.5)
    scores = torch.einsum('bhqd,bhkd->bhqk', q, k) * scale
    ctx_mask = torch.ones((B, 1, T, C), dtype=scores.dtype)
    tm = tree_mask[:, None, :, :].clone()
    full_mask = torch.concatenate([ctx_mask, tm], axis=-1)
    scores = scores + (1.0 - full_mask) * -1000000000.0
    p = _softmax(scores, axis=-1)
    return torch.einsum('bhqk,bhkd->bhqd', p, v)
```

```asm
; @launch grid=(256,1,1) block=(256,1,1) lds=45568
.amdgcn_target "amdgcn-amd-amdhsa--gfx950"
.text
.globl standalone__tree_speculative_verify_tree_attention_over_candidate_token_tree__sampling_kernel
.p2align 8
.type standalone__tree_speculative_verify_tree_attention_over_candidate_token_tree__sampling_kernel,@function
standalone__tree_speculative_verify_tree_attention_over_candidate_token_tree__sampling_kernel:
    s_cmp_ge_u32 s2, 256
    s_cbranch_scc1 L_end
    s_mov_b32 s3, 0
    s_load_dwordx16 s[4:19], s[0:1], 0
    s_load_dwordx2 s[20:21], s[0:1], 64
    v_readfirstlane_b32 s33, v0
    v_and_b32 v1, 63, v0
    v_and_b32 v4, 3, v0
    v_bfe_u32 v5, v0, 2, 2
    v_and_b32 v8, 48, v0
    s_lshr_b32 s33, s33, 6
    s_lshr_b32 s39, s2, 3
    s_bfe_u32 s38, s2, 0x10001
    s_lshl1_add_u32 s34, s39, s38
    s_bfe_u32 s38, s2, 0x10002
    s_and_b32 s39, s2, 1
    s_lshl1_add_u32 s35, s38, s39
    s_lshl2_add_u32 s48, s38, s33
    s_lshl_b32 s48, s48, 1
    s_cmp_lg_u32 s39, 0
    s_cselect_b32 s58, 0x1fcc00, 0
    s_cselect_b32 s51, 22, 12
    s_add_u32 s48, s48, 0
    s_add_u32 s49, s48, 16
    s_and_b32 s59, s48, 0x4
    s_lshl_b32 s59, s59, 8
    s_xor_b32 s52, s59, s58
    s_and_b32 s59, s48, 0x12
    s_lshl_b32 s59, s59, 10
    s_xor_b32 s52, s59, s52
    s_and_b32 s59, s48, 0x1e0
    s_lshl_b32 s59, s59, 12
    s_xor_b32 s52, s59, s52
    s_and_b32 s59, s48, 0x8
    s_lshl_b32 s59, s59, 13
    s_xor_b32 s52, s59, s52
    s_and_b32 s59, s48, 0x601
    s_lshl_b32 s59, s59, 15
    s_xor_b32 s52, s59, s52
    s_xor_b32 s53, s52, 0x4000
    s_xor_b32 s54, s52, 0x8000
    s_xor_b32 s55, s53, 0x8000
    s_mov_b32 s26, 0x200000
    s_mov_b32 s27, 0x20000
    s_mov_b32 s30, 0x200000
    s_mov_b32 s31, 0x20000
    s_mov_b32 s32, 0x3e0293ee
    v_lshlrev_b32 v3, 4, v1
    v_lshlrev_b32 v15, 2, v8
    v_lshl_or_b32 v15, v4, 4, v15
    v_lshl_or_b32 v68, v5, 8, v15
    v_or_b32 v69, 0x1000, v68
    v_or_b32 v224, 0x2000, v68
    v_or_b32 v225, 0x3000, v68
    s_lshl_b32 s38, s34, 10
    v_add_u32 v9, s38, v68
    s_lshl_b32 s38, s34, 21
    s_or_b32 s50, s35, s33
    s_waitcnt lgkmcnt(0)
    s_add_u32 s24, s6, s38
    s_addc_u32 s25, s7, 0
    buffer_load_dwordx4 v[76:79], v68, s[24:27], s52 offen offset:0 nt
    buffer_load_dwordx4 v[80:83], v69, s[24:27], s52 offen offset:0 nt
    buffer_load_dwordx4 v[84:87], v224, s[24:27], s52 offen offset:0 nt
    buffer_load_dwordx4 v[88:91], v225, s[24:27], s52 offen offset:0 nt
    global_load_dwordx4 v[48:51], v9, s[4:5]
    s_cmp_lg_u32 s50, 0
    s_cbranch_scc1 L_notree_ld
    s_lshl_b32 s39, s34, 8
    v_add_u32 v14, s39, v15
    global_load_dwordx4 v[148:151], v14, s[10:11]
    v_and_b32 v15, 0xf0, v3
    v_add_u32 v15, s39, v15
    global_load_dwordx4 v[164:167], v15, s[12:13]
    s_lshr_b32 s39, s34, 3
    s_lshl_b32 s39, s39, 1
    v_mov_b32 v14, s39
    global_load_ushort v168, v14, s[14:15]
L_notree_ld:
    buffer_load_dwordx4 v[108:111], v68, s[24:27], s54 offen offset:0 nt
    buffer_load_dwordx4 v[112:115], v69, s[24:27], s54 offen offset:0 nt
    buffer_load_dwordx4 v[116:119], v224, s[24:27], s54 offen offset:0 nt
    buffer_load_dwordx4 v[120:123], v225, s[24:27], s54 offen offset:0 nt
    buffer_load_dwordx4 v[92:95], v68, s[24:27], s53 offen offset:0 nt
    buffer_load_dwordx4 v[96:99], v69, s[24:27], s53 offen offset:0 nt
    buffer_load_dwordx4 v[100:103], v224, s[24:27], s53 offen offset:0 nt
    buffer_load_dwordx4 v[104:107], v225, s[24:27], s53 offen offset:0 nt
    buffer_load_dwordx4 v[124:127], v68, s[24:27], s55 offen offset:0 nt
    buffer_load_dwordx4 v[128:131], v69, s[24:27], s55 offen offset:0 nt
    buffer_load_dwordx4 v[132:135], v224, s[24:27], s55 offen offset:0 nt
    buffer_load_dwordx4 v[136:139], v225, s[24:27], s55 offen offset:0 nt
    s_add_u32 s28, s8, s38
    s_addc_u32 s29, s9, 0
    v_or_b32 v146, 0x1000, v3
    v_or_b32 v226, 0x2000, v3
    v_or_b32 v227, 0x3000, v3
    s_lshl_b32 s38, s33, 1
    s_sub_u32 s38, s48, s38
    v_lshl_add_u32 v16, v0, 4, s38
    v_lshlrev_b32 v16, s51, v16
    v_or_b32 v17, 4, v16
    s_bitcmp1_b32 s2, 0
    s_cselect_b32 s38, 13, 15
    v_bfrev_b32 v16, 1
    v_cmp_gt_u32 vcc, s38, v0
    v_mov_b32 v75, 0
    v_lshlrev_b32 v15, 3, v0
    v_cndmask_b32 v16, v16, v17, vcc
    v_cmp_ge_u32 vcc, s38, v0
    v_mov_b32 v144, 8320
    v_mov_b32 v17, 0
    v_cndmask_b32 v16, 0, v16, vcc
    v_mov_b32 v20, 0
    v_mov_b32 v21, 16
    ds_write_b64 v15, v[16:17] offset:8448
    v_mov_b32 v22, 104
    v_mov_b32 v23, 0x7d
    ds_write_b128 v144, v[20:23]
    v_mov_b32 v25, 8
    v_mov_b32 v26, 768
    v_mov_b32 v27, 0xfffff7ed
    v_mov_b32 v24, 0
    ds_write_b128 v144, v[24:27] offset:16
    v_mov_b32 v40, 0
    v_mov_b32 v41, 0
    v_mov_b32 v42, 0
    v_mov_b32 v43, 0
    v_mov_b32 v44, 0
    v_mov_b32 v45, 0
    v_mov_b32 v46, 0
    v_mov_b32 v47, 0
    v_mov_b32 v230, 8320
    v_and_b32 v233, 1, s2
    v_lshlrev_b32 v233, 6, v233
    v_mov_b32 v145, 2
    v_mov_b32 v70, 0
    s_xor_b32 s22, s51, 0xa001a
    s_or_b32 s51, s51, 0xa0000
    s_lshl_b32 s39, s34, 8
    s_add_u32 s39, s39, 0x300000
    s_add_u32 s44, s20, s39
    s_addc_u32 s45, s21, 0
    s_lshl_b32 s38, s34, 14
    s_add_u32 s62, s20, s38
    s_addc_u32 s63, s21, 0
    s_lshl_b32 s38, s35, 12
    v_or_b32 v31, s38, v3
    s_lshl_b32 s38, s33, 11
    v_or_b32 v2, s38, v3
    v_mov_b32 v14, 0x0c0c0c0c
    v_mov_b32 v15, 0x0c0c0100
    v_cmp_eq_u32 vcc, 0, v4
    s_nop 1
    v_cndmask_b32 v10, v14, v15, vcc
    v_mov_b32 v15, 0x01000c0c
    v_cmp_eq_u32 vcc, 1, v4
    s_nop 1
    v_cndmask_b32 v10, v10, v15, vcc
    v_mov_b32 v15, 0x0c0c0100
    v_cmp_eq_u32 vcc, 2, v4
    s_nop 1
    v_cndmask_b32 v11, v14, v15, vcc
    v_mov_b32 v15, 0x01000c0c
    v_cmp_eq_u32 vcc, 3, v4
    s_nop 1
    v_cndmask_b32 v11, v11, v15, vcc
    v_mov_b32 v15, 0x0c0c0302
    v_cmp_eq_u32 vcc, 0, v4
    s_nop 1
    v_cndmask_b32 v12, v14, v15, vcc
    v_mov_b32 v15, 0x03020c0c
    v_cmp_eq_u32 vcc, 1, v4
    s_nop 1
    v_cndmask_b32 v12, v12, v15, vcc
    v_mov_b32 v15, 0x0c0c0302
    v_cmp_eq_u32 vcc, 2, v4
    s_nop 1
    v_cndmask_b32 v13, v14, v15, vcc
    v_mov_b32 v15, 0x03020c0c
    v_cmp_eq_u32 vcc, 3, v4
    s_nop 1
    v_cndmask_b32 v13, v13, v15, vcc
    v_mov_b32 v6, 0xff7fffff
    v_mov_b32 v7, 0
    v_lshrrev_b32 v228, 2, v1
    v_cmp_gt_u32 vcc, 32, v1
    v_lshlrev_b32 v228, 4, v228
    v_add_u32 v229, -1, v228
    v_cndmask_b32 v9, 0, -8, vcc
    s_mov_b32 s14, s52
    s_xor_b32 s13, s58, 0x0
    s_mov_b32 s4, -1
    s_mov_b32 s5, 0
    s_lshl_b32 s66, s33, 9
    s_add_u32 s67, s66, 2048
    s_mov_b32 s68, 0x11111111
    s_mov_b32 s69, 0x11111111
    s_mov_b64 s[46:47], 0
    s_mov_b64 s[60:61], 1
    s_mov_b32 s57, 0
    s_mov_b32 s36, 4
    s_waitcnt lgkmcnt(0)
    s_barrier
    s_cmp_lg_u32 s50, 0
    s_cbranch_scc1 L_notree
    s_waitcnt vmcnt(12)
    v_mfma_f32_16x16x32_bf16 v[52:55], v[148:151], v[48:51], 0
    v_lshlrev_b32 v14, 16, v168
    v_sub_f32 v14, 1.0, v14
    v_mul_f32 v14, 0xceabfb8f, v14
    v_mov_b32 v7, 0x3e800000
    v_lshlrev_b32 v40, 16, v164
    v_and_b32 v41, 0xffff0000, v164
    v_lshlrev_b32 v42, 16, v165
    v_and_b32 v43, 0xffff0000, v165
    v_lshlrev_b32 v44, 16, v166
    v_and_b32 v45, 0xffff0000, v166
    v_lshlrev_b32 v46, 16, v167
    v_and_b32 v47, 0xffff0000, v167
    v_mov_b32_dpp v16, v52 quad_perm:[0,0,0,0] row_mask:0xf bank_mask:0xf
    s_nop 1
    v_add_f32_dpp v16, v53, v16 quad_perm:[1,1,1,1] row_mask:0xf bank_mask:0xf
    s_nop 1
    v_add_f32_dpp v16, v54, v16 quad_perm:[2,2,2,2] row_mask:0xf bank_mask:0xf
    s_nop 1
    v_add_f32_dpp v16, v55, v16 quad_perm:[3,3,3,3] row_mask:0xf bank_mask:0xf
    s_nop 1
    v_fma_f32 v6, v16, s32, v14
    s_and_b32 s38, s2, 31
    s_cbranch_scc1 L_notree
    s_call_b64 s[42:43], L_elect
L_notree:
    s_mov_b64 exec, s[60:61]
    ds_add_rtn_u32 v70, v230, v145 offset:4
    s_mov_b64 exec, -1
    s_waitcnt lgkmcnt(0)
    v_cmp_le_u32 vcc, s4, v70
    v_add_u32 v232, s5, v70
    s_nop 0
    v_cndmask_b32 v232, v70, v232, vcc
    v_and_b32 v71, -8, v232
    ds_read_b64 v[72:73], v71 offset:8448
L1_0:
    s_bitcmp1_b32 s66, 0
    s_cbranch_scc1 L2_0
    v_readfirstlane_b32 s37, v232
    v_add_u32 v147, s66, v228
    s_lshr_b32 s12, s66, 8
    s_waitcnt vmcnt(12) lgkmcnt(0)
    v_readfirstlane_b32 s56, v72
    v_mfma_f32_16x16x32_bf16 v[52:55], v[76:79], v[48:51], 0
    v_mfma_f32_16x16x32_bf16 v[56:59], v[80:83], v[48:51], 0
    v_mfma_f32_16x16x32_bf16 v[60:63], v[84:87], v[48:51], 0
    v_mfma_f32_16x16x32_bf16 v[64:67], v[88:91], v[48:51], 0
    s_bitcmp1_b32 s67, 0
    s_cbranch_scc1 L_mv0
    s_cmp_eq_u32 s56, 0
    s_cbranch_scc1 L_waitA0
L_waitretA0:
    s_bfe_u32 s38, s56, s51
    s_bfe_u32 s39, s56, s22
    s_and_b32 s40, s37, 6
    s_add_u32 s39, s39, s38
    s_add_u32 s38, s38, s40
    s_cmp_ge_u32 s39, 512
    s_cbranch_scc1 L_sw0
    s_and_b32 s59, s38, 0x4
    s_lshl_b32 s59, s59, 8
    s_xor_b32 s52, s59, s58
    s_and_b32 s59, s38, 0x12
    s_lshl_b32 s59, s59, 10
    s_xor_b32 s52, s59, s52
    s_and_b32 s59, s38, 0x1e0
    s_lshl_b32 s59, s59, 12
    s_xor_b32 s52, s59, s52
    s_and_b32 s59, s38, 0x8
    s_lshl_b32 s59, s59, 13
    s_xor_b32 s52, s59, s52
    s_and_b32 s59, s38, 0x601
    s_lshl_b32 s59, s59, 15
    s_xor_b32 s52, s59, s52
    s_lshl_b32 s66, s37, 8
    s_and_b32 s39, s56, 4
    buffer_load_dwordx4 v[76:79], v68, s[24:27], s52 offen offset:0 nt
    buffer_load_dwordx4 v[80:83], v69, s[24:27], s52 offen offset:0 nt
    buffer_load_dwordx4 v[84:87], v224, s[24:27], s52 offen offset:0 nt
    buffer_load_dwordx4 v[88:91], v225, s[24:27], s52 offen offset:0 nt
    s_xor_b32 s54, s52, 0x8000
    s_or_b32 s39, s39, s40
    s_cbranch_scc0 L_claimA0
L_claimretA0:
L_claimretM0:
    v_mov_b32_dpp v16, v52 quad_perm:[0,0,0,0] row_mask:0xf bank_mask:0xf
    v_mov_b32_dpp v17, v56 quad_perm:[0,0,0,0] row_mask:0xf bank_mask:0xf
    v_mov_b32_dpp v18, v60 quad_perm:[0,0,0,0] row_mask:0xf bank_mask:0xf
    v_mov_b32_dpp v19, v64 quad_perm:[0,0,0,0] row_mask:0xf bank_mask:0xf
    v_add_f32_dpp v16, v53, v16 quad_perm:[1,1,1,1] row_mask:0xf bank_mask:0xf
    v_add_f32_dpp v17, v57, v17 quad_perm:[1,1,1,1] row_mask:0xf bank_mask:0xf
    v_add_f32_dpp v18, v61, v18 quad_perm:[1,1,1,1] row_mask:0xf bank_mask:0xf
    v_add_f32_dpp v19, v65, v19 quad_perm:[1,1,1,1] row_mask:0xf bank_mask:0xf
    v_add_f32_dpp v16, v54, v16 quad_perm:[2,2,2,2] row_mask:0xf bank_mask:0xf
    v_add_f32_dpp v17, v58, v17 quad_perm:[2,2,2,2] row_mask:0xf bank_mask:0xf
    v_add_f32_dpp v18, v62, v18 quad_perm:[2,2,2,2] row_mask:0xf bank_mask:0xf
    v_add_f32_dpp v19, v66, v19 quad_perm:[2,2,2,2] row_mask:0xf bank_mask:0xf
    v_add_f32_dpp v16, v55, v16 quad_perm:[3,3,3,3] row_mask:0xf bank_mask:0xf
    v_add_f32_dpp v17, v59, v17 quad_perm:[3,3,3,3] row_mask:0xf bank_mask:0xf
    v_add_f32_dpp v18, v63, v18 quad_perm:[3,3,3,3] row_mask:0xf bank_mask:0xf
    v_add_f32_dpp v19, v67, v19 quad_perm:[3,3,3,3] row_mask:0xf bank_mask:0xf
    s_mov_b64 exec, s[68:69]
    ds_write_b128 v147, v[16:19] offset:10752
    s_mov_b64 exec, -1
    s_waitcnt vmcnt(12)
    s_mov_b64 exec, s[60:61]
    ds_add_rtn_u32 v70, v230, v145 offset:4
    s_mov_b64 exec, -1
    v_mfma_f32_16x16x32_bf16 v[52:55], v[108:111], v[48:51], 0
    v_mfma_f32_16x16x32_bf16 v[56:59], v[112:115], v[48:51], 0
    v_mfma_f32_16x16x32_bf16 v[60:63], v[116:119], v[48:51], 0
    v_mfma_f32_16x16x32_bf16 v[64:67], v[120:123], v[48:51], 0
    s_bitcmp1_b32 s66, 0
    s_cbranch_scc1 L_yv0
    buffer_load_dwordx4 v[108:111], v68, s[24:27], s54 offen offset:0 nt
    buffer_load_dwordx4 v[112:115], v69, s[24:27], s54 offen offset:0 nt
    buffer_load_dwordx4 v[116:119], v224, s[24:27], s54 offen offset:0 nt
    buffer_load_dwordx4 v[120:123], v225, s[24:27], s54 offen offset:0 nt
L_yvret0:
    s_bfe_u32 s38, s12, 0x20001
    s_and_b32 s39, s12, -8
    s_or_b32 s38, s38, s39
    s_waitcnt lgkmcnt(0)
    v_mov_b32 v140, s38
    s_cmp_lg_u32 s46, 0
    s_cbranch_scc1 L_pubA0
L_pubretA0:
    v_cmp_le_u32 vcc, s4, v70
    v_add_u32 v232, s5, v70
    s_nop 0
    v_cndmask_b32 v232, v70, v232, vcc
    v_and_b32 v71, -8, v232
    ds_read_b64 v[72:73], v71 offset:8448
    v_mov_b32 v14, v140
    v_mov_b32_dpp v16, v52 quad_perm:[0,0,0,0] row_mask:0xf bank_mask:0xf
    v_mov_b32_dpp v17, v56 quad_perm:[0,0,0,0] row_mask:0xf bank_mask:0xf
    v_mov_b32_dpp v18, v60 quad_perm:[0,0,0,0] row_mask:0xf bank_mask:0xf
    v_mov_b32_dpp v19, v64 quad_perm:[0,0,0,0] row_mask:0xf bank_mask:0xf
    v_add_f32_dpp v16, v53, v16 quad_perm:[1,1,1,1] row_mask:0xf bank_mask:0xf
    v_add_f32_dpp v17, v57, v17 quad_perm:[1,1,1,1] row_mask:0xf bank_mask:0xf
    v_add_f32_dpp v18, v61, v18 quad_perm:[1,1,1,1] row_mask:0xf bank_mask:0xf
    v_add_f32_dpp v19, v65, v19 quad_perm:[1,1,1,1] row_mask:0xf bank_mask:0xf
    v_add_f32_dpp v16, v54, v16 quad_perm:[2,2,2,2] row_mask:0xf bank_mask:0xf
    v_add_f32_dpp v17, v58, v17 quad_perm:[2,2,2,2] row_mask:0xf bank_mask:0xf
    v_add_f32_dpp v18, v62, v18 quad_perm:[2,2,2,2] row_mask:0xf bank_mask:0xf
    v_add_f32_dpp v19, v66, v19 quad_perm:[2,2,2,2] row_mask:0xf bank_mask:0xf
    v_add_f32_dpp v16, v55, v16 quad_perm:[3,3,3,3] row_mask:0xf bank_mask:0xf
    v_add_f32_dpp v17, v59, v17 quad_perm:[3,3,3,3] row_mask:0xf bank_mask:0xf
    v_add_f32_dpp v18, v63, v18 quad_perm:[3,3,3,3] row_mask:0xf bank_mask:0xf
    v_add_f32_dpp v19, v67, v19 quad_perm:[3,3,3,3] row_mask:0xf bank_mask:0xf
    s_mov_b64 exec, s[68:69]
    ds_write_b128 v147, v[16:19] offset:11008
    s_mov_b64 exec, 1
    ds_write_b8 v14, v145 offset:8452
    s_mov_b64 exec, -1
L1_1:
    s_bitcmp1_b32 s67, 0
    s_cbranch_scc1 L2_1
    v_readfirstlane_b32 s37, v232
    v_add_u32 v147, s67, v228
    s_lshr_b32 s12, s67, 8
    s_waitcnt vmcnt(12) lgkmcnt(0)
    v_readfirstlane_b32 s56, v72
    v_mfma_f32_16x16x32_bf16 v[52:55], v[92:95], v[48:51], 0
    v_mfma_f32_16x16x32_bf16 v[56:59], v[96:99], v[48:51], 0
    v_mfma_f32_16x16x32_bf16 v[60:63], v[100:103], v[48:51], 0
    v_mfma_f32_16x16x32_bf16 v[64:67], v[104:107], v[48:51], 0
    s_bitcmp1_b32 s66, 0
    s_cbranch_scc1 L_mv1
    s_cmp_eq_u32 s56, 0
    s_cbranch_scc1 L_waitA1
L_waitretA1:
    s_bfe_u32 s38, s56, s51
    s_bfe_u32 s39, s56, s22
    s_and_b32 s40, s37, 6
    s_add_u32 s39, s39, s38
    s_add_u32 s38, s38, s40
    s_cmp_ge_u32 s39, 512
    s_cbranch_scc1 L_sw1
    s_and_b32 s59, s38, 0x4
    s_lshl_b32 s59, s59, 8
    s_xor_b32 s53, s59, s58
    s_and_b32 s59, s38, 0x12
    s_lshl_b32 s59, s59, 10
    s_xor_b32 s53, s59, s53
    s_and_b32 s59, s38, 0x1e0
    s_lshl_b32 s59, s59, 12
    s_xor_b32 s53, s59, s53
    s_and_b32 s59, s38, 0x8
    s_lshl_b32 s59, s59, 13
    s_xor_b32 s53, s59, s53
    s_and_b32 s59, s38, 0x601
    s_lshl_b32 s59, s59, 15
    s_xor_b32 s53, s59, s53
    s_lshl_b32 s67, s37, 8
    s_and_b32 s39, s56, 4
    buffer_load_dwordx4 v[92:95], v68, s[24:27], s53 offen offset:0 nt
    buffer_load_dwordx4 v[96:99], v69, s[24:27], s53 offen offset:0 nt
    buffer_load_dwordx4 v[100:103], v224, s[24:27], s53 offen offset:0 nt
    buffer_load_dwordx4 v[104:107], v225, s[24:27], s53 offen offset:0 nt
    s_xor_b32 s54, s53, 0x8000
    s_or_b32 s39, s39, s40
    s_cbranch_scc0 L_claimA1
L_claimretA1:
L_claimretM1:
    v_mov_b32_dpp v16, v52 quad_perm:[0,0,0,0] row_mask:0xf bank_mask:0xf
    v_mov_b32_dpp v17, v56 quad_perm:[0,0,0,0] row_mask:0xf bank_mask:0xf
    v_mov_b32_dpp v18, v60 quad_perm:[0,0,0,0] row_mask:0xf bank_mask:0xf
    v_mov_b32_dpp v19, v64 quad_perm:[0,0,0,0] row_mask:0xf bank_mask:0xf
    v_add_f32_dpp v16, v53, v16 quad_perm:[1,1,1,1] row_mask:0xf bank_mask:0xf
    v_add_f32_dpp v17, v57, v17 quad_perm:[1,1,1,1] row_mask:0xf bank_mask:0xf
    v_add_f32_dpp v18, v61, v18 quad_perm:[1,1,1,1] row_mask:0xf bank_mask:0xf
    v_add_f32_dpp v19, v65, v19 quad_perm:[1,1,1,1] row_mask:0xf bank_mask:0xf
    v_add_f32_dpp v16, v54, v16 quad_perm:[2,2,2,2] row_mask:0xf bank_mask:0xf
    v_add_f32_dpp v17, v58, v17 quad_perm:[2,2,2,2] row_mask:0xf bank_mask:0xf
    v_add_f32_dpp v18, v62, v18 quad_perm:[2,2,2,2] row_mask:0xf bank_mask:0xf
    v_add_f32_dpp v19, v66, v19 quad_perm:[2,2,2,2] row_mask:0xf bank_mask:0xf
    v_add_f32_dpp v16, v55, v16 quad_perm:[3,3,3,3] row_mask:0xf bank_mask:0xf
    v_add_f32_dpp v17, v59, v17 quad_perm:[3,3,3,3] row_mask:0xf bank_mask:0xf
    v_add_f32_dpp v18, v63, v18 quad_perm:[3,3,3,3] row_mask:0xf bank_mask:0xf
    v_add_f32_dpp v19, v67, v19 quad_perm:[3,3,3,3] row_mask:0xf bank_mask:0xf
    s_mov_b64 exec, s[68:69]
    ds_write_b128 v147, v[16:19] offset:10752
    s_mov_b64 exec, -1
    s_waitcnt vmcnt(12)
    s_mov_b64 exec, s[60:61]
    ds_add_rtn_u32 v70, v230, v145 offset:4
    s_mov_b64 exec, -1
    v_mfma_f32_16x16x32_bf16 v[52:55], v[124:127], v[48:51], 0
    v_mfma_f32_16x16x32_bf16 v[56:59], v[128:131], v[48:51], 0
    v_mfma_f32_16x16x32_bf16 v[60:63], v[132:135], v[48:51], 0
    v_mfma_f32_16x16x32_bf16 v[64:67], v[136:139], v[48:51], 0
    s_bitcmp1_b32 s67, 0
    s_cbranch_scc1 L_yv1
    buffer_load_dwordx4 v[124:127], v68, s[24:27], s54 offen offset:0 nt
    buffer_load_dwordx4 v[128:131], v69, s[24:27], s54 offen offset:0 nt
    buffer_load_dwordx4 v[132:135], v224, s[24:27], s54 offen offset:0 nt
    buffer_load_dwordx4 v[136:139], v225, s[24:27], s54 offen offset:0 nt
L_yvret1:
    s_bfe_u32 s38, s12, 0x20001
    s_and_b32 s39, s12, -8
    s_or_b32 s38, s38, s39
    s_waitcnt lgkmcnt(0)
    v_mov_b32 v140, s38
    s_cmp_lg_u32 s47, 0
    s_cbranch_scc1 L_pubA1
L_pubretA1:
    v_cmp_le_u32 vcc, s4, v70
    v_add_u32 v232, s5, v70
    s_nop 0
    v_cndmask_b32 v232, v70, v232, vcc
    v_and_b32 v71, -8, v232
    ds_read_b64 v[72:73], v71 offset:8448
    v_mov_b32 v14, v140
    v_mov_b32_dpp v16, v52 quad_perm:[0,0,0,0] row_mask:0xf bank_mask:0xf
    v_mov_b32_dpp v17, v56 quad_perm:[0,0,0,0] row_mask:0xf bank_mask:0xf
    v_mov_b32_dpp v18, v60 quad_perm:[0,0,0,0] row_mask:0xf bank_mask:0xf
    v_mov_b32_dpp v19, v64 quad_perm:[0,0,0,0] row_mask:0xf bank_mask:0xf
    v_add_f32_dpp v16, v53, v16 quad_perm:[1,1,1,1] row_mask:0xf bank_mask:0xf
    v_add_f32_dpp v17, v57, v17 quad_perm:[1,1,1,1] row_mask:0xf bank_mask:0xf
    v_add_f32_dpp v18, v61, v18 quad_perm:[1,1,1,1] row_mask:0xf bank_mask:0xf
    v_add_f32_dpp v19, v65, v19 quad_perm:[1,1,1,1] row_mask:0xf bank_mask:0xf
    v_add_f32_dpp v16, v54, v16 quad_perm:[2,2,2,2] row_mask:0xf bank_mask:0xf
    v_add_f32_dpp v17, v58, v17 quad_perm:[2,2,2,2] row_mask:0xf bank_mask:0xf
    v_add_f32_dpp v18, v62, v18 quad_perm:[2,2,2,2] row_mask:0xf bank_mask:0xf
    v_add_f32_dpp v19, v66, v19 quad_perm:[2,2,2,2] row_mask:0xf bank_mask:0xf
    v_add_f32_dpp v16, v55, v16 quad_perm:[3,3,3,3] row_mask:0xf bank_mask:0xf
    v_add_f32_dpp v17, v59, v17 quad_perm:[3,3,3,3] row_mask:0xf bank_mask:0xf
    v_add_f32_dpp v18, v63, v18 quad_perm:[3,3,3,3] row_mask:0xf bank_mask:0xf
    v_add_f32_dpp v19, v67, v19 quad_perm:[3,3,3,3] row_mask:0xf bank_mask:0xf
    s_mov_b64 exec, s[68:69]
    ds_write_b128 v147, v[16:19] offset:11008
    s_mov_b64 exec, 1
    ds_write_b8 v14, v145 offset:8452
    s_mov_b64 exec, -1
    s_sub_u32 s36, s36, 1
    s_cbranch_scc0 L1_0
    s_load_dword s57, s[18:19], 4
    s_branch L1_0
L2_0:
    s_and_b32 s38, s66, 6
    s_cbranch_scc1 L_odd0
    v_add_u32 v147, s66, v229
    v_readfirstlane_b32 s37, v232
    ds_read_b128 v[16:19], v147 offset:10752
    ds_read_b128 v[156:159], v147 offset:11008
L_missret0:
    s_waitcnt lgkmcnt(0)
    v_readfirstlane_b32 s56, v72
    v_readfirstlane_b32 s7, v73
    v_fma_f32 v20, v16, s32, -v6
    v_fma_f32 v21, v17, s32, -v6
    v_fma_f32 v22, v18, s32, -v6
    v_fma_f32 v23, v19, s32, -v6
    v_max3_f32 v4, v20, v21, v22
    v_max_f32 v4, v4, v23
    v_cmp_lt_f32 vcc, 0, v4
    s_cbranch_vccnz L_stubX0
L_backX0:
    v_exp_f32 v24, v20
    v_exp_f32 v25, v21
    v_exp_f32 v26, v22
    v_exp_f32 v27, v23
    v_add_f32 v7, v7, v24
    v_cvt_pk_bf16_f32 v28, v24, v25
    v_add_f32 v7, v7, v25
    v_cvt_pk_bf16_f32 v29, v26, v27
    v_add_f32 v7, v7, v26
    v_perm_b32 v32, v28, v28, v10
    v_perm_b32 v33, v28, v28, v11
    v_perm_b32 v34, v28, v28, v12
    v_perm_b32 v35, v28, v28, v13
    v_perm_b32 v36, v29, v29, v10
    v_perm_b32 v37, v29, v29, v11
    v_perm_b32 v38, v29, v29, v12
    v_perm_b32 v39, v29, v29, v13
    v_add_f32 v7, v7, v27
    s_waitcnt vmcnt(12)
    v_mfma_f32_16x16x16_bf16 v[40:43], v[32:33], v[76:77], v[40:43]
    v_mfma_f32_16x16x16_bf16 v[44:47], v[32:33], v[78:79], v[44:47]
    v_mfma_f32_16x16x16_bf16 v[40:43], v[34:35], v[80:81], v[40:43]
    v_mfma_f32_16x16x16_bf16 v[44:47], v[34:35], v[82:83], v[44:47]
    v_mfma_f32_16x16x16_bf16 v[40:43], v[36:37], v[84:85], v[40:43]
    v_mfma_f32_16x16x16_bf16 v[44:47], v[36:37], v[86:87], v[44:47]
    v_mfma_f32_16x16x16_bf16 v[40:43], v[38:39], v[88:89], v[40:43]
    v_mfma_f32_16x16x16_bf16 v[44:47], v[38:39], v[90:91], v[44:47]
    s_cmp_ge_u32 s37, 768
    s_cbranch_scc1 L_g3B0
    s_bfe_u32 s38, s56, s51
    s_and_b32 s40, s37, 6
    s_add_u32 s38, s38, s40
    s_and_b32 s59, s38, 0x4
    s_lshl_b32 s59, s59, 8
    s_xor_b32 s52, s59, s58
    s_and_b32 s59, s38, 0x12
    s_lshl_b32 s59, s59, 10
    s_xor_b32 s52, s59, s52
    s_and_b32 s59, s38, 0x1e0
    s_lshl_b32 s59, s59, 12
    s_xor_b32 s52, s59, s52
    s_and_b32 s59, s38, 0x8
    s_lshl_b32 s59, s59, 13
    s_xor_b32 s52, s59, s52
    s_and_b32 s59, s38, 0x601
    s_lshl_b32 s59, s59, 15
    s_xor_b32 s52, s59, s52
    s_lshl2_add_u32 s41, s40, 1
    s_lshl_b32 s38, s37, 8
    buffer_load_dwordx4 v[76:79], v3, s[28:31], s52 offen offset:0 nt
    buffer_load_dwordx4 v[80:83], v146, s[28:31], s52 offen offset:0 nt
    buffer_load_dwordx4 v[84:87], v226, s[28:31], s52 offen offset:0 nt
    buffer_load_dwordx4 v[88:91], v227, s[28:31], s52 offen offset:0 nt
    s_bitcmp1_b32 s7, s41
    s_cselect_b32 s39, 1, 3
    s_or_b32 s66, s38, s39
    s_xor_b32 s54, s52, 0x8000
    s_cmp_ge_u32 s37, s6
    s_cbranch_scc1 L_trigB0
L_claimretB0:
    v_fma_f32 v20, v156, s32, -v6
    v_fma_f32 v21, v157, s32, -v6
    v_fma_f32 v22, v158, s32, -v6
    v_fma_f32 v23, v159, s32, -v6
    v_max3_f32 v4, v20, v21, v22
    v_max_f32 v4, v4, v23
    v_cmp_lt_f32 vcc, 0, v4
    s_cbranch_vccnz L_stubY0
L_backY0:
    v_exp_f32 v24, v20
    v_exp_f32 v25, v21
    v_exp_f32 v26, v22
    v_exp_f32 v27, v23
    v_add_f32 v7, v7, v24
    v_cvt_pk_bf16_f32 v28, v24, v25
    v_add_f32 v7, v7, v25
    v_cvt_pk_bf16_f32 v29, v26, v27
    v_add_f32 v7, v7, v26
    v_perm_b32 v32, v28, v28, v10
    v_perm_b32 v33, v28, v28, v11
    v_perm_b32 v34, v28, v28, v12
    v_perm_b32 v35, v28, v28, v13
    v_perm_b32 v36, v29, v29, v10
    v_perm_b32 v37, v29, v29, v11
    v_perm_b32 v38, v29, v29, v12
    v_perm_b32 v39, v29, v29, v13
    v_add_f32 v7, v7, v27
    s_waitcnt vmcnt(12)
    s_mov_b64 exec, s[60:61]
    ds_add_rtn_u32 v70, v144, v145 offset:20
    s_mov_b64 exec, -1
    v_mfma_f32_16x16x16_bf16 v[40:43], v[32:33], v[108:109], v[40:43]
    v_mfma_f32_16x16x16_bf16 v[44:47], v[32:33], v[110:111], v[44:47]
    v_mfma_f32_16x16x16_bf16 v[40:43], v[34:35], v[112:113], v[40:43]
    v_mfma_f32_16x16x16_bf16 v[44:47], v[34:35], v[114:115], v[44:47]
    v_mfma_f32_16x16x16_bf16 v[40:43], v[36:37], v[116:117], v[40:43]
    v_mfma_f32_16x16x16_bf16 v[44:47], v[36:37], v[118:119], v[44:47]
    v_mfma_f32_16x16x16_bf16 v[40:43], v[38:39], v[120:121], v[40:43]
    v_mfma_f32_16x16x16_bf16 v[44:47], v[38:39], v[122:123], v[44:47]
    buffer_load_dwordx4 v[108:111], v3, s[28:31], s54 offen offset:0 nt
    buffer_load_dwordx4 v[112:115], v146, s[28:31], s54 offen offset:0 nt
    buffer_load_dwordx4 v[116:119], v226, s[28:31], s54 offen offset:0 nt
    buffer_load_dwordx4 v[120:123], v227, s[28:31], s54 offen offset:0 nt
    s_waitcnt lgkmcnt(0)
    s_cmp_lg_u32 s46, 0
    s_cbranch_scc1 L_pubB0
L_pubretB0:
    v_cmp_le_u32 vcc, s4, v70
    v_add_u32 v232, s5, v70
    s_nop 0
    v_cndmask_b32 v232, v70, v232, vcc
    v_and_b32 v71, -8, v232
    ds_read_b64 v[72:73], v71 offset:8448
L2_1:
    s_and_b32 s38, s67, 6
    s_cbranch_scc1 L_odd1
    v_add_u32 v147, s67, v229
    v_readfirstlane_b32 s37, v232
    ds_read_b128 v[16:19], v147 offset:10752
    ds_read_b128 v[156:159], v147 offset:11008
L_missret1:
    s_waitcnt lgkmcnt(0)
    v_readfirstlane_b32 s56, v72
    v_readfirstlane_b32 s7, v73
    v_fma_f32 v20, v16, s32, -v6
    v_fma_f32 v21, v17, s32, -v6
    v_fma_f32 v22, v18, s32, -v6
    v_fma_f32 v23, v19, s32, -v6
    v_max3_f32 v4, v20, v21, v22
    v_max_f32 v4, v4, v23
    v_cmp_lt_f32 vcc, 0, v4
    s_cbranch_vccnz L_stubX1
L_backX1:
    v_exp_f32 v24, v20
    v_exp_f32 v25, v21
    v_exp_f32 v26, v22
    v_exp_f32 v27, v23
    v_add_f32 v7, v7, v24
    v_cvt_pk_bf16_f32 v28, v24, v25
    v_add_f32 v7, v7, v25
    v_cvt_pk_bf16_f32 v29, v26, v27
    v_add_f32 v7, v7, v26
    v_perm_b32 v32, v28, v28, v10
    v_perm_b32 v33, v28, v28, v11
    v_perm_b32 v34, v28, v28, v12
    v_perm_b32 v35, v28, v28, v13
    v_perm_b32 v36, v29, v29, v10
    v_perm_b32 v37, v29, v29, v11
    v_perm_b32 v38, v29, v29, v12
    v_perm_b32 v39, v29, v29, v13
    v_add_f32 v7, v7, v27
    s_waitcnt vmcnt(12)
    v_mfma_f32_16x16x16_bf16 v[40:43], v[32:33], v[92:93], v[40:43]
    v_mfma_f32_16x16x16_bf16 v[44:47], v[32:33], v[94:95], v[44:47]
    v_mfma_f32_16x16x16_bf16 v[40:43], v[34:35], v[96:97], v[40:43]
    v_mfma_f32_16x16x16_bf16 v[44:47], v[34:35], v[98:99], v[44:47]
    v_mfma_f32_16x16x16_bf16 v[40:43], v[36:37], v[100:101], v[40:43]
    v_mfma_f32_16x16x16_bf16 v[44:47], v[36:37], v[102:103], v[44:47]
    v_mfma_f32_16x16x16_bf16 v[40:43], v[38:39], v[104:105], v[40:43]
    v_mfma_f32_16x16x16_bf16 v[44:47], v[38:39], v[106:107], v[44:47]
    s_cmp_ge_u32 s37, 768
    s_cbranch_scc1 L_g3B1
    s_bfe_u32 s38, s56, s51
    s_and_b32 s40, s37, 6
    s_add_u32 s38, s38, s40
    s_and_b32 s59, s38, 0x4
    s_lshl_b32 s59, s59, 8
    s_xor_b32 s53, s59, s58
    s_and_b32 s59, s38, 0x12
    s_lshl_b32 s59, s59, 10
    s_xor_b32 s53, s59, s53
    s_and_b32 s59, s38, 0x1e0
    s_lshl_b32 s59, s59, 12
    s_xor_b32 s53, s59, s53
    s_and_b32 s59, s38, 0x8
    s_lshl_b32 s59, s59, 13
    s_xor_b32 s53, s59, s53
    s_and_b32 s59, s38, 0x601
    s_lshl_b32 s59, s59, 15
    s_xor_b32 s53, s59, s53
    s_lshl2_add_u32 s41, s40, 1
    s_lshl_b32 s38, s37, 8
    buffer_load_dwordx4 v[92:95], v3, s[28:31], s53 offen offset:0 nt
    buffer_load_dwordx4 v[96:99], v146, s[28:31], s53 offen offset:0 nt
    buffer_load_dwordx4 v[100:103], v226, s[28:31], s53 offen offset:0 nt
    buffer_load_dwordx4 v[104:107], v227, s[28:31], s53 offen offset:0 nt
    s_bitcmp1_b32 s7, s41
    s_cselect_b32 s39, 1, 3
    s_or_b32 s67, s38, s39
    s_xor_b32 s54, s53, 0x8000
    s_cmp_ge_u32 s37, s6
    s_cbranch_scc1 L_trigB1
L_claimretB1:
    v_fma_f32 v20, v156, s32, -v6
    v_fma_f32 v21, v157, s32, -v6
    v_fma_f32 v22, v158, s32, -v6
    v_fma_f32 v23, v159, s32, -v6
    v_max3_f32 v4, v20, v21, v22
    v_max_f32 v4, v4, v23
    v_cmp_lt_f32 vcc, 0, v4
    s_cbranch_vccnz L_stubY1
L_backY1:
    v_exp_f32 v24, v20
    v_exp_f32 v25, v21
    v_exp_f32 v26, v22
    v_exp_f32 v27, v23
    v_add_f32 v7, v7, v24
    v_cvt_pk_bf16_f32 v28, v24, v25
    v_add_f32 v7, v7, v25
    v_cvt_pk_bf16_f32 v29, v26, v27
    v_add_f32 v7, v7, v26
    v_perm_b32 v32, v28, v28, v10
    v_perm_b32 v33, v28, v28, v11
    v_perm_b32 v34, v28, v28, v12
    v_perm_b32 v35, v28, v28, v13
    v_perm_b32 v36, v29, v29, v10
    v_perm_b32 v37, v29, v29, v11
    v_perm_b32 v38, v29, v29, v12
    v_perm_b32 v39, v29, v29, v13
    v_add_f32 v7, v7, v27
    s_waitcnt vmcnt(12)
    s_mov_b64 exec, s[60:61]
    ds_add_rtn_u32 v70, v144, v145 offset:20
    s_mov_b64 exec, -1
    v_mfma_f32_16x16x16_bf16 v[40:43], v[32:33], v[124:125], v[40:43]
    v_mfma_f32_16x16x16_bf16 v[44:47], v[32:33], v[126:127], v[44:47]
    v_mfma_f32_16x16x16_bf16 v[40:43], v[34:35], v[128:129], v[40:43]
    v_mfma_f32_16x16x16_bf16 v[44:47], v[34:35], v[130:131], v[44:47]
    v_mfma_f32_16x16x16_bf16 v[40:43], v[36:37], v[132:133], v[40:43]
    v_mfma_f32_16x16x16_bf16 v[44:47], v[36:37], v[134:135], v[44:47]
    v_mfma_f32_16x16x16_bf16 v[40:43], v[38:39], v[136:137], v[40:43]
    v_mfma_f32_16x16x16_bf16 v[44:47], v[38:39], v[138:139], v[44:47]
    buffer_load_dwordx4 v[124:127], v3, s[28:31], s54 offen offset:0 nt
    buffer_load_dwordx4 v[128:131], v146, s[28:31], s54 offen offset:0 nt
    buffer_load_dwordx4 v[132:135], v226, s[28:31], s54 offen offset:0 nt
    buffer_load_dwordx4 v[136:139], v227, s[28:31], s54 offen offset:0 nt
    s_waitcnt lgkmcnt(0)
    s_cmp_lg_u32 s47, 0
    s_cbranch_scc1 L_pubB1
L_pubretB1:
    v_cmp_le_u32 vcc, s4, v70
    v_add_u32 v232, s5, v70
    s_nop 0
    v_cndmask_b32 v232, v70, v232, vcc
    v_and_b32 v71, -8, v232
    ds_read_b64 v[72:73], v71 offset:8448
    s_branch L2_0
L3_0:
    s_cmp_ge_u32 s48, 0x200
    s_cbranch_scc1 L_exit
    v_readfirstlane_b32 s37, v232
    s_waitcnt vmcnt(12) lgkmcnt(0)
    v_readfirstlane_b32 s56, v72
    v_mfma_f32_16x16x32_bf16 v[52:55], v[76:79], v[48:51], 0
    v_mfma_f32_16x16x32_bf16 v[56:59], v[80:83], v[48:51], 0
    v_mfma_f32_16x16x32_bf16 v[60:63], v[84:87], v[48:51], 0
    v_mfma_f32_16x16x32_bf16 v[64:67], v[88:91], v[48:51], 0
    s_cmp_eq_u32 s56, 0
    s_cbranch_scc1 L_waitC0
L_waitretC0:
    s_bfe_u32 s38, s56, s51
    s_bfe_u32 s39, s56, s22
    s_add_u32 s39, s39, s38
    s_bfe_u32 s40, s37, 0x20001
    s_add_u32 s38, s38, s40
    s_cmp_lt_u32 s39, 512
    s_cselect_b32 s48, s38, s39
    s_cselect_b32 s60, 1, 0
    s_cselect_b32 s40, s40, 2
    s_and_b32 s59, s48, 0x4
    s_lshl_b32 s59, s59, 8
    s_xor_b32 s52, s59, s13
    s_and_b32 s59, s48, 0x12
    s_lshl_b32 s59, s59, 10
    s_xor_b32 s52, s59, s52
    s_and_b32 s59, s48, 0x1e0
    s_lshl_b32 s59, s59, 12
    s_xor_b32 s52, s59, s52
    s_and_b32 s59, s48, 0x8
    s_lshl_b32 s59, s59, 13
    s_xor_b32 s52, s59, s52
    s_and_b32 s59, s48, 0x601
    s_lshl_b32 s59, s59, 15
    s_xor_b32 s52, s59, s52
    s_cmp_eq_u32 s40, 3
    buffer_load_dwordx4 v[76:79], v68, s[24:27], s52 offen offset:0 nt
    buffer_load_dwordx4 v[80:83], v69, s[24:27], s52 offen offset:0 nt
    buffer_load_dwordx4 v[84:87], v224, s[24:27], s52 offen offset:0 nt
    buffer_load_dwordx4 v[88:91], v225, s[24:27], s52 offen offset:0 nt
    s_cbranch_scc1 L_claimC0
L_claimretC0:
    v_mov_b32_dpp v16, v52 quad_perm:[0,0,0,0] row_mask:0xf bank_mask:0xf
    v_mov_b32_dpp v17, v56 quad_perm:[0,0,0,0] row_mask:0xf bank_mask:0xf
    v_mov_b32_dpp v18, v60 quad_perm:[0,0,0,0] row_mask:0xf bank_mask:0xf
    v_mov_b32_dpp v19, v64 quad_perm:[0,0,0,0] row_mask:0xf bank_mask:0xf
    v_add_f32_dpp v16, v53, v16 quad_perm:[1,1,1,1] row_mask:0xf bank_mask:0xf
    v_add_f32_dpp v17, v57, v17 quad_perm:[1,1,1,1] row_mask:0xf bank_mask:0xf
    v_add_f32_dpp v18, v61, v18 quad_perm:[1,1,1,1] row_mask:0xf bank_mask:0xf
    v_add_f32_dpp v19, v65, v19 quad_perm:[1,1,1,1] row_mask:0xf bank_mask:0xf
    v_add_f32_dpp v16, v54, v16 quad_perm:[2,2,2,2] row_mask:0xf bank_mask:0xf
    v_add_f32_dpp v17, v58, v17 quad_perm:[2,2,2,2] row_mask:0xf bank_mask:0xf
    v_add_f32_dpp v18, v62, v18 quad_perm:[2,2,2,2] row_mask:0xf bank_mask:0xf
    v_add_f32_dpp v19, v66, v19 quad_perm:[2,2,2,2] row_mask:0xf bank_mask:0xf
    v_add_f32_dpp v16, v55, v16 quad_perm:[3,3,3,3] row_mask:0xf bank_mask:0xf
    v_add_f32_dpp v17, v59, v17 quad_perm:[3,3,3,3] row_mask:0xf bank_mask:0xf
    v_add_f32_dpp v18, v63, v18 quad_perm:[3,3,3,3] row_mask:0xf bank_mask:0xf
    v_add_f32_dpp v19, v67, v19 quad_perm:[3,3,3,3] row_mask:0xf bank_mask:0xf
    v_fma_f32 v20, v16, s32, -v6
    v_fma_f32 v21, v17, s32, -v6
    v_fma_f32 v22, v18, s32, -v6
    v_fma_f32 v23, v19, s32, -v6
    v_max3_f32 v4, v20, v21, v22
    v_max_f32 v4, v4, v23
    v_cmp_lt_f32 vcc, 0, v4
    s_cbranch_vccnz L_stubZ0
L_backZ0:
    v_exp_f32 v24, v20
    v_exp_f32 v25, v21
    v_exp_f32 v26, v22
    v_exp_f32 v27, v23
    v_add_f32 v7, v7, v24
    v_cvt_pk_bf16_f32 v28, v24, v25
    v_add_f32 v7, v7, v25
    v_cvt_pk_bf16_f32 v29, v26, v27
    v_add_f32 v7, v7, v26
    v_perm_b32 v32, v28, v28, v10
    v_perm_b32 v33, v28, v28, v11
    v_perm_b32 v34, v28, v28, v12
    v_perm_b32 v35, v28, v28, v13
    v_perm_b32 v36, v29, v29, v10
    v_perm_b32 v37, v29, v29, v11
    v_perm_b32 v38, v29, v29, v12
    v_perm_b32 v39, v29, v29, v13
    v_add_f32 v7, v7, v27
    s_waitcnt vmcnt(12)
    s_mov_b64 exec, s[60:61]
    ds_add_rtn_u32 v70, v144, v145 offset:20
    s_mov_b64 exec, -1
    v_mfma_f32_16x16x16_bf16 v[40:43], v[32:33], v[108:109], v[40:43]
    v_mfma_f32_16x16x16_bf16 v[44:47], v[32:33], v[110:111], v[44:47]
    v_mfma_f32_16x16x16_bf16 v[40:43], v[34:35], v[112:113], v[40:43]
    v_mfma_f32_16x16x16_bf16 v[44:47], v[34:35], v[114:115], v[44:47]
    v_mfma_f32_16x16x16_bf16 v[40:43], v[36:37], v[116:117], v[40:43]
    v_mfma_f32_16x16x16_bf16 v[44:47], v[36:37], v[118:119], v[44:47]
    v_mfma_f32_16x16x16_bf16 v[40:43], v[38:39], v[120:121], v[40:43]
    v_mfma_f32_16x16x16_bf16 v[44:47], v[38:39], v[122:123], v[44:47]
    buffer_load_dwordx4 v[108:111], v3, s[28:31], s52 offen offset:0 nt
    buffer_load_dwordx4 v[112:115], v146, s[28:31], s52 offen offset:0 nt
    buffer_load_dwordx4 v[116:119], v226, s[28:31], s52 offen offset:0 nt
    buffer_load_dwordx4 v[120:123], v227, s[28:31], s52 offen offset:0 nt
    s_waitcnt lgkmcnt(0)
    s_cmp_lg_u32 s46, 0
    s_cbranch_scc1 L_pubC0
L_pubretC0:
    v_add_u32 v232, s5, v70
    v_and_b32 v71, -8, v232
    ds_read_b64 v[72:73], v71 offset:8448
L3_1:
    s_cmp_ge_u32 s49, 0x200
    s_cbranch_scc1 L_exit
    v_readfirstlane_b32 s37, v232
    s_waitcnt vmcnt(12) lgkmcnt(0)
    v_readfirstlane_b32 s56, v72
    v_mfma_f32_16x16x32_bf16 v[52:55], v[92:95], v[48:51], 0
    v_mfma_f32_16x16x32_bf16 v[56:59], v[96:99], v[48:51], 0
    v_mfma_f32_16x16x32_bf16 v[60:63], v[100:103], v[48:51], 0
    v_mfma_f32_16x16x32_bf16 v[64:67], v[104:107], v[48:51], 0
    s_cmp_eq_u32 s56, 0
    s_cbranch_scc1 L_waitC1
L_waitretC1:
    s_bfe_u32 s38, s56, s51
    s_bfe_u32 s39, s56, s22
    s_add_u32 s39, s39, s38
    s_bfe_u32 s40, s37, 0x20001
    s_add_u32 s38, s38, s40
    s_cmp_lt_u32 s39, 512
    s_cselect_b32 s49, s38, s39
    s_cselect_b32 s60, 1, 0
    s_cselect_b32 s40, s40, 2
    s_and_b32 s59, s49, 0x4
    s_lshl_b32 s59, s59, 8
    s_xor_b32 s53, s59, s13
    s_and_b32 s59, s49, 0x12
    s_lshl_b32 s59, s59, 10
    s_xor_b32 s53, s59, s53
    s_and_b32 s59, s49, 0x1e0
    s_lshl_b32 s59, s59, 12
    s_xor_b32 s53, s59, s53
    s_and_b32 s59, s49, 0x8
    s_lshl_b32 s59, s59, 13
    s_xor_b32 s53, s59, s53
    s_and_b32 s59, s49, 0x601
    s_lshl_b32 s59, s59, 15
    s_xor_b32 s53, s59, s53
    s_cmp_eq_u32 s40, 3
    buffer_load_dwordx4 v[92:95], v68, s[24:27], s53 offen offset:0 nt
    buffer_load_dwordx4 v[96:99], v69, s[24:27], s53 offen offset:0 nt
    buffer_load_dwordx4 v[100:103], v224, s[24:27], s53 offen offset:0 nt
    buffer_load_dwordx4 v[104:107], v225, s[24:27], s53 offen offset:0 nt
    s_cbranch_scc1 L_claimC1
L_claimretC1:
    v_mov_b32_dpp v16, v52 quad_perm:[0,0,0,0] row_mask:0xf bank_mask:0xf
    v_mov_b32_dpp v17, v56 quad_perm:[0,0,0,0] row_mask:0xf bank_mask:0xf
    v_mov_b32_dpp v18, v60 quad_perm:[0,0,0,0] row_mask:0xf bank_mask:0xf
    v_mov_b32_dpp v19, v64 quad_perm:[0,0,0,0] row_mask:0xf bank_mask:0xf
    v_add_f32_dpp v16, v53, v16 quad_perm:[1,1,1,1] row_mask:0xf bank_mask:0xf
    v_add_f32_dpp v17, v57, v17 quad_perm:[1,1,1,1] row_mask:0xf bank_mask:0xf
    v_add_f32_dpp v18, v61, v18 quad_perm:[1,1,1,1] row_mask:0xf bank_mask:0xf
    v_add_f32_dpp v19, v65, v19 quad_perm:[1,1,1,1] row_mask:0xf bank_mask:0xf
    v_add_f32_dpp v16, v54, v16 quad_perm:[2,2,2,2] row_mask:0xf bank_mask:0xf
    v_add_f32_dpp v17, v58, v17 quad_perm:[2,2,2,2] row_mask:0xf bank_mask:0xf
    v_add_f32_dpp v18, v62, v18 quad_perm:[2,2,2,2] row_mask:0xf bank_mask:0xf
    v_add_f32_dpp v19, v66, v19 quad_perm:[2,2,2,2] row_mask:0xf bank_mask:0xf
    v_add_f32_dpp v16, v55, v16 quad_perm:[3,3,3,3] row_mask:0xf bank_mask:0xf
    v_add_f32_dpp v17, v59, v17 quad_perm:[3,3,3,3] row_mask:0xf bank_mask:0xf
    v_add_f32_dpp v18, v63, v18 quad_perm:[3,3,3,3] row_mask:0xf bank_mask:0xf
    v_add_f32_dpp v19, v67, v19 quad_perm:[3,3,3,3] row_mask:0xf bank_mask:0xf
    v_fma_f32 v20, v16, s32, -v6
    v_fma_f32 v21, v17, s32, -v6
    v_fma_f32 v22, v18, s32, -v6
    v_fma_f32 v23, v19, s32, -v6
    v_max3_f32 v4, v20, v21, v22
    v_max_f32 v4, v4, v23
    v_cmp_lt_f32 vcc, 0, v4
    s_cbranch_vccnz L_stubZ1
L_backZ1:
    v_exp_f32 v24, v20
    v_exp_f32 v25, v21
    v_exp_f32 v26, v22
    v_exp_f32 v27, v23
    v_add_f32 v7, v7, v24
    v_cvt_pk_bf16_f32 v28, v24, v25
    v_add_f32 v7, v7, v25
    v_cvt_pk_bf16_f32 v29, v26, v27
    v_add_f32 v7, v7, v26
    v_perm_b32 v32, v28, v28, v10
    v_perm_b32 v33, v28, v28, v11
    v_perm_b32 v34, v28, v28, v12
    v_perm_b32 v35, v28, v28, v13
    v_perm_b32 v36, v29, v29, v10
    v_perm_b32 v37, v29, v29, v11
    v_perm_b32 v38, v29, v29, v12
    v_perm_b32 v39, v29, v29, v13
    v_add_f32 v7, v7, v27
    s_waitcnt vmcnt(12)
    s_mov_b64 exec, s[60:61]
    ds_add_rtn_u32 v70, v144, v145 offset:20
    s_mov_b64 exec, -1
    v_mfma_f32_16x16x16_bf16 v[40:43], v[32:33], v[124:125], v[40:43]
    v_mfma_f32_16x16x16_bf16 v[44:47], v[32:33], v[126:127], v[44:47]
    v_mfma_f32_16x16x16_bf16 v[40:43], v[34:35], v[128:129], v[40:43]
    v_mfma_f32_16x16x16_bf16 v[44:47], v[34:35], v[130:131], v[44:47]
    v_mfma_f32_16x16x16_bf16 v[40:43], v[36:37], v[132:133], v[40:43]
    v_mfma_f32_16x16x16_bf16 v[44:47], v[36:37], v[134:135], v[44:47]
    v_mfma_f32_16x16x16_bf16 v[40:43], v[38:39], v[136:137], v[40:43]
    v_mfma_f32_16x16x16_bf16 v[44:47], v[38:39], v[138:139], v[44:47]
    buffer_load_dwordx4 v[124:127], v3, s[28:31], s53 offen offset:0 nt
    buffer_load_dwordx4 v[128:131], v146, s[28:31], s53 offen offset:0 nt
    buffer_load_dwordx4 v[132:135], v226, s[28:31], s53 offen offset:0 nt
    buffer_load_dwordx4 v[136:139], v227, s[28:31], s53 offen offset:0 nt
    s_waitcnt lgkmcnt(0)
    s_cmp_lg_u32 s47, 0
    s_cbranch_scc1 L_pubC1
L_pubretC1:
    v_add_u32 v232, s5, v70
    v_and_b32 v71, -8, v232
    ds_read_b64 v[72:73], v71 offset:8448
    s_branch L3_0
L_exit:
    v_mov_b32 v4, v7
    s_lshl3_add_u32 s38, s33, 8192
    v_lshl_add_u32 v14, v5, 5, s38
    v_permlane32_swap_b32 v4, v7
    v_add_f32 v7, v7, v4
    v_mov_b32 v4, v7
    ds_write_b128 v2, v[40:43]
    ds_write_b128 v2, v[44:47] offset:1024
    v_permlane16_swap_b32 v4, v7
    v_add_f32 v7, v7, v4
    v_mov_b32 v17, 1
    v_and_b32 v16, s37, v9
    v_add_u32 v16, v16, v231
    s_mov_b64 exec, 0x1111
    ds_write_b64 v14, v[6:7]
    s_mov_b64 exec, 1
    ds_add_rtn_u32 v18, v144, v17
    s_mov_b64 exec, -1
    ds_read_b64 v[24:25], v16 offset:8448
    v_lshlrev_b32 v15, 1, v8
    ds_read_b128 v[148:151], v15 offset:8192
    ds_read_b128 v[152:155], v15 offset:8208
    ds_read_b128 v[156:159], v3 offset:0
    ds_read_b128 v[160:163], v3 offset:1024
    v_xor_b32 v20, 0x1000, v31
    v_xor_b32 v21, 0x2000, v31
    v_xor_b32 v22, 0x3000, v31
    s_waitcnt lgkmcnt(4)
    v_readfirstlane_b32 s38, v18
    v_bfe_u32 v14, v24, 12, 10
    v_lshrrev_b32 v19, 22, v24
    v_readfirstlane_b32 s39, v25
    v_add3_u32 v14, v14, v19, -1
    s_cmp_lt_u32 s38, 3
    v_cmp_gt_u32 vcc, 0x1ff, v14
    s_cbranch_scc1 L_endp
    s_cbranch_vccnz L_left
    s_mov_b64 exec, 1
    global_atomic_add v18, v75, v17, s[44:45] offset:128 sc0 sc1
    s_mov_b64 exec, -1
    global_load_dwordx4 v[196:199], v20, s[62:63] offset:2048 sc1
    global_load_dwordx4 v[208:211], v21, s[62:63] offset:2048 sc1
    global_load_dwordx4 v[220:223], v22, s[62:63] offset:2048 sc1
    global_load_dwordx4 v[188:191], v20, s[62:63] offset:0 sc1
    global_load_dwordx4 v[200:203], v21, s[62:63] offset:0 sc1
    global_load_dwordx4 v[212:215], v22, s[62:63] offset:0 sc1
    global_load_dwordx4 v[192:195], v20, s[62:63] offset:1024 sc1
    global_load_dwordx4 v[204:207], v21, s[62:63] offset:1024 sc1
    global_load_dwordx4 v[216:219], v22, s[62:63] offset:1024 sc1
    ds_read_b128 v[164:167], v3 offset:2048
    ds_read_b128 v[168:171], v3 offset:3072
    ds_read_b128 v[172:175], v3 offset:4096
    ds_read_b128 v[176:179], v3 offset:5120
    ds_read_b128 v[180:183], v3 offset:6144
    ds_read_b128 v[184:187], v3 offset:7168
    s_lshl_b32 s38, s34, 10
    s_add_u32 s40, s16, s38
    s_addc_u32 s41, s17, 0
    v_mov_b32 v35, s39
    v_mov_b32 v39, s39
    v_mov_b32 v43, s39
    s_waitcnt lgkmcnt(8)
    v_max3_f32 v6, v148, v150, v152
    v_max_f32 v6, v6, v154
    v_sub_f32 v24, v148, v6
    v_sub_f32 v25, v150, v6
    v_sub_f32 v26, v152, v6
    v_sub_f32 v27, v154, v6
    v_exp_f32 v24, v24
    v_exp_f32 v25, v25
    v_exp_f32 v26, v26
    v_exp_f32 v27, v27
    v_mul_f32 v7, v24, v149
    v_fmac_f32 v7, v25, v151
    v_fmac_f32 v7, v26, v153
    v_fmac_f32 v7, v27, v155
    v_rcp_f32 v29, v7
    v_log_f32 v7, v7
    v_pk_mul_f32 v[24:25], v[24:25], v[28:29] op_sel:[0,1] op_sel_hi:[1,1]
    v_pk_mul_f32 v[26:27], v[26:27], v[28:29] op_sel:[0,1] op_sel_hi:[1,1]
    v_add_f32 v42, v6, v7
    s_waitcnt lgkmcnt(6)
    v_pk_mul_f32 v[32:33], v[156:157], v[24:25] op_sel:[0,0] op_sel_hi:[1,0]
    v_pk_mul_f32 v[36:37], v[158:159], v[24:25] op_sel:[0,0] op_sel_hi:[1,0]
    v_pk_mul_f32 v[40:41], v[160:161], v[24:25] op_sel:[0,0] op_sel_hi:[1,0]
    v_mul_f32 v34, v162, v24
    v_mul_f32 v38, v163, v24
    s_waitcnt lgkmcnt(4)
    v_pk_fma_f32 v[32:33], v[164:165], v[24:25], v[32:33] op_sel:[0,1,0] op_sel_hi:[1,1,1]
    v_pk_fma_f32 v[36:37], v[166:167], v[24:25], v[36:37] op_sel:[0,1,0] op_sel_hi:[1,1,1]
    v_pk_fma_f32 v[40:41], v[168:169], v[24:25], v[40:41] op_sel:[0,1,0] op_sel_hi:[1,1,1]
    v_fmac_f32 v34, v170, v25
    v_fmac_f32 v38, v171, v25
    s_waitcnt lgkmcnt(2)
    v_pk_fma_f32 v[32:33], v[172:173], v[26:27], v[32:33] op_sel:[0,0,0] op_sel_hi:[1,0,1]
    v_pk_fma_f32 v[36:37], v[174:175], v[26:27], v[36:37] op_sel:[0,0,0] op_sel_hi:[1,0,1]
    v_pk_fma_f32 v[40:41], v[176:177], v[26:27], v[40:41] op_sel:[0,0,0] op_sel_hi:[1,0,1]
    v_fmac_f32 v34, v178, v26
    v_fmac_f32 v38, v179, v26
    s_waitcnt lgkmcnt(0)
    v_pk_fma_f32 v[32:33], v[180:181], v[26:27], v[32:33] op_sel:[0,1,0] op_sel_hi:[1,1,1]
    v_pk_fma_f32 v[36:37], v[182:183], v[26:27], v[36:37] op_sel:[0,1,0] op_sel_hi:[1,1,1]
    v_pk_fma_f32 v[40:41], v[184:185], v[26:27], v[40:41] op_sel:[0,1,0] op_sel_hi:[1,1,1]
    v_fmac_f32 v34, v186, v27
    v_fmac_f32 v38, v187, v27
    global_store_dwordx4 v31, v[40:43], s[62:63] offset:2048 sc1
    global_store_dwordx4 v31, v[32:35], s[62:63] offset:0 sc1
    global_store_dwordx4 v31, v[36:39], s[62:63] offset:1024 sc1
    s_waitcnt vmcnt(12)
    v_readfirstlane_b32 s38, v18
    s_and_b32 s38, s38, 3
    s_cmp_lg_u32 s38, 3
    s_cbranch_scc1 L_endp
L_final:
    s_mov_b64 s[42:43], exec
    s_waitcnt vmcnt(9)
    v_max3_f32 v28, v42, v198, v210
    v_max_f32 v28, v28, v222
    v_sub_f32 v24, v42, v28
    v_sub_f32 v25, v198, v28
    v_sub_f32 v26, v210, v28
    v_sub_f32 v27, v222, v28
    v_exp_f32 v24, v24
    v_exp_f32 v25, v25
    v_exp_f32 v26, v26
    v_exp_f32 v27, v27
    v_add_f32 v29, v24, v25
    v_add_f32 v29, v29, v26
    v_add_f32 v29, v29, v27
    v_rcp_f32 v29, v29
    v_cmpx_eq_u32 vcc, s39, v199
    v_cmpx_eq_u32 vcc, s39, v211
    v_cmpx_eq_u32 vcc, s39, v223
    v_pk_mul_f32 v[24:25], v[24:25], v[28:29] op_sel:[0,1] op_sel_hi:[1,1]
    v_pk_mul_f32 v[26:27], v[26:27], v[28:29] op_sel:[0,1] op_sel_hi:[1,1]
    v_pk_mul_f32 v[152:153], v[40:41], v[24:25] op_sel:[0,0] op_sel_hi:[1,0]
    v_pk_mul_f32 v[148:149], v[32:33], v[24:25] op_sel:[0,0] op_sel_hi:[1,0]
    v_pk_mul_f32 v[150:151], v[36:37], v[24:25] op_sel:[0,0] op_sel_hi:[1,0]
    v_mul_f32 v154, v34, v24
    v_mul_f32 v155, v38, v24
    v_pk_fma_f32 v[152:153], v[196:197], v[24:25], v[152:153] op_sel:[0,1,0] op_sel_hi:[1,1,1]
    v_pk_fma_f32 v[152:153], v[208:209], v[26:27], v[152:153] op_sel:[0,0,0] op_sel_hi:[1,0,1]
    v_pk_fma_f32 v[152:153], v[220:221], v[26:27], v[152:153] op_sel:[0,1,0] op_sel_hi:[1,1,1]
    s_waitcnt vmcnt(6)
    v_cmpx_eq_u32 vcc, s39, v191
    v_cmpx_eq_u32 vcc, s39, v203
    v_cmpx_eq_u32 vcc, s39, v215
    v_pk_fma_f32 v[148:149], v[188:189], v[24:25], v[148:149] op_sel:[0,1,0] op_sel_hi:[1,1,1]
    v_fmac_f32 v154, v190, v25
    v_pk_fma_f32 v[148:149], v[200:201], v[26:27], v[148:149] op_sel:[0,0,0] op_sel_hi:[1,0,1]
    v_fmac_f32 v154, v202, v26
    v_pk_fma_f32 v[148:149], v[212:213], v[26:27], v[148:149] op_sel:[0,1,0] op_sel_hi:[1,1,1]
    v_fmac_f32 v154, v214, v27
    v_cvt_pk_bf16_f32 v158, v152, v153
    v_cvt_pk_bf16_f32 v156, v148, v149
    s_waitcnt vmcnt(3)
    v_cmpx_eq_u32 vcc, s39, v195
    v_cmpx_eq_u32 vcc, s39, v207
    v_cmpx_eq_u32 vcc, s39, v219
    v_pk_fma_f32 v[150:151], v[192:193], v[24:25], v[150:151] op_sel:[0,1,0] op_sel_hi:[1,1,1]
    v_fmac_f32 v155, v194, v25
    v_pk_fma_f32 v[150:151], v[204:205], v[26:27], v[150:151] op_sel:[0,0,0] op_sel_hi:[1,0,1]
    v_fmac_f32 v155, v206, v26
    v_pk_fma_f32 v[150:151], v[216:217], v[26:27], v[150:151] op_sel:[0,1,0] op_sel_hi:[1,1,1]
    v_fmac_f32 v155, v218, v27
    v_cvt_pk_bf16_f32 v157, v150, v151
    v_cvt_pk_bf16_f32 v159, v154, v155
    global_store_dwordx4 v3, v[156:159], s[40:41]
    s_andn2_b64 exec, s[42:43], exec
    s_cbranch_scc1 L_retry
L_endp:
L_end:
    s_endpgm
L_retry:
    s_add_u32 s50, s50, 1
    s_cmp_gt_u32 s50, 200000
    s_cbranch_scc1 L_endp
    global_load_dwordx4 v[196:199], v20, s[62:63] offset:2048 sc1
    global_load_dwordx4 v[208:211], v21, s[62:63] offset:2048 sc1
    global_load_dwordx4 v[220:223], v22, s[62:63] offset:2048 sc1
    global_load_dwordx4 v[188:191], v20, s[62:63] offset:0 sc1
    global_load_dwordx4 v[200:203], v21, s[62:63] offset:0 sc1
    global_load_dwordx4 v[212:215], v22, s[62:63] offset:0 sc1
    global_load_dwordx4 v[192:195], v20, s[62:63] offset:1024 sc1
    global_load_dwordx4 v[204:207], v21, s[62:63] offset:1024 sc1
    global_load_dwordx4 v[216:219], v22, s[62:63] offset:1024 sc1
    global_load_dword v14, v31, s[62:63]
    global_load_dword v15, v31, s[62:63]
    global_load_dword v16, v31, s[62:63]
    s_branch L_final
L_left:
    s_add_u32 s3, s3, 5000
    s_cmp_gt_u32 s3, 10000000
    s_cbranch_scc1 L_endp
    s_ff1_i32_b64 s38, vcc
    s_nop 4
    v_readlane_b32 s56, v24, s38
    v_readlane_b32 s40, v16, s38
    s_mov_b64 exec, 1
    s_cmp_lt_u32 s38, 32
    s_cbranch_scc1 L_left3
    v_mov_b32 v14, s40
    v_bfrev_b32 v18, 1
    v_mov_b32 v19, s39
    ds_write_b32 v14, v18 offset:8448
    s_and_b32 s40, s37, -8
    v_mov_b32 v14, s40
    ds_write_b64 v14, v[18:19] offset:8464
    s_bfe_u32 s38, s56, s51
    s_add_u32 s41, s38, 4
    s_xor_b32 s41, s41, 0
    s_lshl_b32 s41, s41, s51
    s_or_b32 s41, s41, 8
    v_mov_b32 v16, s41
    v_mov_b32 v17, s39
    ds_write_b64 v14, v[16:17] offset:8456
    s_xor_b32 s41, s38, 0
    s_lshl_b32 s41, s41, s51
    s_or_b32 s56, s41, 8
    v_mov_b32 v15, s56
    ds_write_b32 v14, v15 offset:8448
L_left3:
    s_nop 4
    s_add_u32 s40, s40, 4
    s_sub_u32 s40, s40, s5
    v_mov_b32 v14, s40
    ds_write_b32 v144, v14 offset:20
    s_mov_b64 exec, -1
    v_mul_f32 v7, 0.5, v7
    v_mul_f32 v7, 0.5, v7
    s_mov_b64 s[60:61], 1
    s_bfe_u32 s48, s56, s51
    s_add_u32 s49, s48, 1
    s_and_b32 s59, s48, 0x4
    s_lshl_b32 s59, s59, 8
    s_xor_b32 s52, s59, s13
    s_and_b32 s59, s48, 0x12
    s_lshl_b32 s59, s59, 10
    s_xor_b32 s52, s59, s52
    s_and_b32 s59, s48, 0x1e0
    s_lshl_b32 s59, s59, 12
    s_xor_b32 s52, s59, s52
    s_and_b32 s59, s48, 0x8
    s_lshl_b32 s59, s59, 13
    s_xor_b32 s52, s59, s52
    s_and_b32 s59, s48, 0x601
    s_lshl_b32 s59, s59, 15
    s_xor_b32 s52, s59, s52
    s_and_b32 s59, s49, 0x4
    s_lshl_b32 s59, s59, 8
    s_xor_b32 s53, s59, s13
    s_and_b32 s59, s49, 0x12
    s_lshl_b32 s59, s59, 10
    s_xor_b32 s53, s59, s53
    s_and_b32 s59, s49, 0x1e0
    s_lshl_b32 s59, s59, 12
    s_xor_b32 s53, s59, s53
    s_and_b32 s59, s49, 0x8
    s_lshl_b32 s59, s59, 13
    s_xor_b32 s53, s59, s53
    s_and_b32 s59, s49, 0x601
    s_lshl_b32 s59, s59, 15
    s_xor_b32 s53, s59, s53
    s_waitcnt vmcnt(0) lgkmcnt(0)
    buffer_load_dwordx4 v[76:79], v68, s[24:27], s52 offen offset:0 nt
    buffer_load_dwordx4 v[80:83], v69, s[24:27], s52 offen offset:0 nt
    buffer_load_dwordx4 v[84:87], v224, s[24:27], s52 offen offset:0 nt
    buffer_load_dwordx4 v[88:91], v225, s[24:27], s52 offen offset:0 nt
    buffer_load_dwordx4 v[108:111], v3, s[28:31], s52 offen offset:0 nt
    buffer_load_dwordx4 v[112:115], v146, s[28:31], s52 offen offset:0 nt
    buffer_load_dwordx4 v[116:119], v226, s[28:31], s52 offen offset:0 nt
    buffer_load_dwordx4 v[120:123], v227, s[28:31], s52 offen offset:0 nt
    buffer_load_dwordx4 v[92:95], v68, s[24:27], s53 offen offset:0 nt
    buffer_load_dwordx4 v[96:99], v69, s[24:27], s53 offen offset:0 nt
    buffer_load_dwordx4 v[100:103], v224, s[24:27], s53 offen offset:0 nt
    buffer_load_dwordx4 v[104:107], v225, s[24:27], s53 offen offset:0 nt
    buffer_load_dwordx4 v[124:127], v3, s[28:31], s53 offen offset:0 nt
    buffer_load_dwordx4 v[128:131], v146, s[28:31], s53 offen offset:0 nt
    buffer_load_dwordx4 v[132:135], v226, s[28:31], s53 offen offset:0 nt
    buffer_load_dwordx4 v[136:139], v227, s[28:31], s53 offen offset:0 nt
    s_mov_b64 exec, s[60:61]
    ds_add_rtn_u32 v70, v144, v145 offset:20
    s_mov_b64 exec, -1
    s_waitcnt lgkmcnt(0)
    v_add_u32 v232, s5, v70
    v_and_b32 v71, -8, v232
    ds_read_b64 v[72:73], v71 offset:8448
    s_branch L3_0
L_pubA0:
    s_mov_b64 s[38:39], s[10:11]
    s_and_b32 s40, s46, 0xff
    s_lshr_b32 s41, s46, 8
    s_bfm_b64 exec, s40, 0
    v_lshlrev_b32 v14, s51, v1
    v_lshl_add_u32 v16, v1, 3, s41
    v_lshl_add_u32 v14, v14, 2, s38
    v_mov_b32 v15, s39
    s_bfe_u32 s41, s38, 0xa000c
    s_lshr_b32 s38, s38, 22
    s_add_u32 s38, s38, s41
    ds_write_b64 v16, v[14:15] offset:8448
    s_lshl_b32 s41, s38, 1
    s_sub_u32 s41, s41, s64
    s_mov_b64 exec, 1
    v_mov_b32 v17, s41
    s_lshl2_add_u32 s38, s40, s38
    s_mov_b32 s46, 0
    ds_write_b32 v144, v17 offset:28
    s_cmp_lt_u32 s38, 512
    s_cbranch_scc1 L_pubxA0
    v_mov_b32 v18, 0x10008
    ds_add_rtn_u32 v19, v144, v18 offset:24
    v_bfrev_b32 v14, 1
    s_waitcnt lgkmcnt(0)
    v_and_b32 v19, 0xffff, v19
    ds_write_b64 v19, v[14:15] offset:8448
L_pubxA0:
    s_mov_b64 exec, -1
    s_branch L_pubretA0
L_waitA0:
L_waitlA0:
    s_add_u32 s3, s3, 1
    s_cmp_gt_u32 s3, 10000000
    s_cbranch_scc1 L_endp
    ds_read_b64 v[72:73], v71 offset:8448
    s_waitcnt lgkmcnt(0)
    v_readfirstlane_b32 s56, v72
    s_nop 3
    s_cmp_lg_u32 s56, 0
    s_cbranch_scc1 L_waitretA0
    s_branch L_waitlA0
L_claimA0:
    s_branch L_claimretA0
L_pubB0:
    s_mov_b64 s[38:39], s[10:11]
    s_and_b32 s40, s46, 0xff
    s_lshr_b32 s41, s46, 8
    s_bfm_b64 exec, s40, 0
    v_lshlrev_b32 v14, s51, v1
    v_lshl_add_u32 v16, v1, 3, s41
    v_lshl_add_u32 v14, v14, 2, s38
    v_mov_b32 v15, s39
    s_bfe_u32 s41, s38, 0xa000c
    s_lshr_b32 s38, s38, 22
    s_add_u32 s38, s38, s41
    ds_write_b64 v16, v[14:15] offset:8448
    s_lshl_b32 s41, s38, 1
    s_sub_u32 s41, s41, s64
    s_mov_b64 exec, 1
    v_mov_b32 v17, s41
    s_lshl2_add_u32 s38, s40, s38
    s_mov_b32 s46, 0
    ds_write_b32 v144, v17 offset:28
    s_cmp_lt_u32 s38, 512
    s_cbranch_scc1 L_pubxB0
    v_mov_b32 v18, 0x10008
    ds_add_rtn_u32 v19, v144, v18 offset:24
    v_bfrev_b32 v14, 1
    s_waitcnt lgkmcnt(0)
    v_and_b32 v19, 0xffff, v19
    ds_write_b64 v19, v[14:15] offset:8448
L_pubxB0:
    s_mov_b64 exec, -1
    s_branch L_pubretB0
L_waitB0:
L_waitlB0:
    s_add_u32 s3, s3, 1
    s_cmp_gt_u32 s3, 10000000
    s_cbranch_scc1 L_endp
    ds_read_b64 v[72:73], v71 offset:8448
    s_waitcnt lgkmcnt(0)
    v_readfirstlane_b32 s56, v72
    s_nop 3
    s_cmp_lg_u32 s56, 0
    s_cbranch_scc1 L_waitretB0
    s_branch L_waitlB0
L_g3B0:
    s_mov_b32 s66, 5
    s_cmp_eq_u32 s56, 0
    s_cbranch_scc1 L_waitB0
L_waitretB0:
    s_bfe_u32 s38, s56, s51
    s_bfe_u32 s39, s56, s22
    s_add_u32 s39, s39, s38
    s_bfe_u32 s40, s37, 0x20001
    s_add_u32 s38, s38, s40
    s_cmp_lt_u32 s39, 512
    s_cselect_b32 s48, s38, s39
    s_cselect_b32 s60, 1, 0
    s_cselect_b32 s40, s40, 2
    s_and_b32 s59, s48, 0x4
    s_lshl_b32 s59, s59, 8
    s_xor_b32 s52, s59, s13
    s_and_b32 s59, s48, 0x12
    s_lshl_b32 s59, s59, 10
    s_xor_b32 s52, s59, s52
    s_and_b32 s59, s48, 0x1e0
    s_lshl_b32 s59, s59, 12
    s_xor_b32 s52, s59, s52
    s_and_b32 s59, s48, 0x8
    s_lshl_b32 s59, s59, 13
    s_xor_b32 s52, s59, s52
    s_and_b32 s59, s48, 0x601
    s_lshl_b32 s59, s59, 15
    s_xor_b32 s52, s59, s52
    s_cmp_eq_u32 s40, 3
    buffer_load_dwordx4 v[76:79], v68, s[24:27], s52 offen offset:0 nt
    buffer_load_dwordx4 v[80:83], v69, s[24:27], s52 offen offset:0 nt
    buffer_load_dwordx4 v[84:87], v224, s[24:27], s52 offen offset:0 nt
    buffer_load_dwordx4 v[88:91], v225, s[24:27], s52 offen offset:0 nt
    s_mov_b32 s54, s52
    s_cbranch_scc1 L_claimB0
    s_branch L_claimretB0
L_trigB0:
    s_cmp_lg_u32 s40, 6
    s_cbranch_scc1 L_claimretB0
    s_add_u32 s37, s37, s5
L_claimB0:
    s_and_b32 s37, s37, -8
    s_cmp_lg_u32 s57, 0
    s_cbranch_scc1 L_goB0
    s_call_b64 s[40:41], L_check
L_goB0:
    ds_read_b64 v[14:15], v144 offset:24
    s_mul_i32 s40, s37, 3
    s_add_u32 s41, s37, 16
    s_waitcnt lgkmcnt(0)
    v_readfirstlane_b32 s38, v14
    v_readfirstlane_b32 s39, v15
    s_sub_u32 s41, s41, s38
    s_cmp_le_i32 s41, 0
    s_cbranch_scc1 L_claimretB0
    s_add_u32 s39, s39, s38
    s_add_u32 s39, s39, s40
    s_sub_u32 s39, 1024, s39
    s_mul_i32 s39, s39, 6
    s_ashr_i32 s39, s39, 8
    s_min_i32 s39, s39, 2
    s_lshr_b32 s41, s41, 3
    s_max_i32 s39, s39, s41
    s_lshl_b32 s41, s39, 3
    s_mov_b64 exec, 1
    v_mov_b32 v14, s41
    ds_add_rtn_u32 v15, v144, v14 offset:24
    s_lshl_b32 s41, s39, 2
    s_lshl_b32 s10, s41, s51
    s_mov_b32 s11, 0
    s_waitcnt lgkmcnt(0)
    v_readfirstlane_b32 s38, v15
    s_cmp_ge_u32 s38, 0x10000
    s_cbranch_scc1 L_cxB0
    s_atomic_add_x2 s[10:11], s[44:45], 0x80 glc
    s_add_u32 s64, s40, s38
    s_lshl_b32 s38, s38, 8
    s_or_b32 s46, s38, s39
L_cxB0:
    s_mov_b64 exec, -1
    s_branch L_claimretB0
L_waitM0:
L_waitlM0:
    s_add_u32 s3, s3, 1
    s_cmp_gt_u32 s3, 10000000
    s_cbranch_scc1 L_endp
    ds_read_b64 v[72:73], v71 offset:8448
    s_waitcnt lgkmcnt(0)
    v_readfirstlane_b32 s56, v72
    s_nop 3
    s_cmp_lg_u32 s56, 0
    s_cbranch_scc1 L_waitretM0
    s_branch L_waitlM0
L_g3M0:
    s_mov_b32 s66, 5
    s_cmp_eq_u32 s56, 0
    s_cbranch_scc1 L_waitM0
L_waitretM0:
    s_bfe_u32 s38, s56, s51
    s_bfe_u32 s39, s56, s22
    s_add_u32 s39, s39, s38
    s_bfe_u32 s40, s37, 0x20001
    s_add_u32 s38, s38, s40
    s_cmp_lt_u32 s39, 512
    s_cselect_b32 s48, s38, s39
    s_cselect_b32 s60, 1, 0
    s_cselect_b32 s40, s40, 2
    s_and_b32 s59, s48, 0x4
    s_lshl_b32 s59, s59, 8
    s_xor_b32 s52, s59, s13
    s_and_b32 s59, s48, 0x12
    s_lshl_b32 s59, s59, 10
    s_xor_b32 s52, s59, s52
    s_and_b32 s59, s48, 0x1e0
    s_lshl_b32 s59, s59, 12
    s_xor_b32 s52, s59, s52
    s_and_b32 s59, s48, 0x8
    s_lshl_b32 s59, s59, 13
    s_xor_b32 s52, s59, s52
    s_and_b32 s59, s48, 0x601
    s_lshl_b32 s59, s59, 15
    s_xor_b32 s52, s59, s52
    s_cmp_eq_u32 s40, 3
    buffer_load_dwordx4 v[76:79], v68, s[24:27], s52 offen offset:0 nt
    buffer_load_dwordx4 v[80:83], v69, s[24:27], s52 offen offset:0 nt
    buffer_load_dwordx4 v[84:87], v224, s[24:27], s52 offen offset:0 nt
    buffer_load_dwordx4 v[88:91], v225, s[24:27], s52 offen offset:0 nt
    s_mov_b32 s54, s52
    s_cbranch_scc1 L_claimM0
    s_branch L_claimretM0
L_trigM0:
    s_cmp_lg_u32 s40, 6
    s_cbranch_scc1 L_claimretM0
    s_add_u32 s37, s37, s5
L_claimM0:
    s_and_b32 s37, s37, -8
    s_cmp_lg_u32 s57, 0
    s_cbranch_scc1 L_goM0
    s_call_b64 s[40:41], L_check
L_goM0:
    ds_read_b64 v[14:15], v144 offset:24
    s_mul_i32 s40, s37, 3
    s_add_u32 s41, s37, 16
    s_waitcnt lgkmcnt(0)
    v_readfirstlane_b32 s38, v14
    v_readfirstlane_b32 s39, v15
    s_sub_u32 s41, s41, s38
    s_cmp_le_i32 s41, 0
    s_cbranch_scc1 L_claimretM0
    s_add_u32 s39, s39, s38
    s_add_u32 s39, s39, s40
    s_sub_u32 s39, 1024, s39
    s_mul_i32 s39, s39, 6
    s_ashr_i32 s39, s39, 8
    s_min_i32 s39, s39, 2
    s_lshr_b32 s41, s41, 3
    s_max_i32 s39, s39, s41
    s_lshl_b32 s41, s39, 3
    s_mov_b64 exec, 1
    v_mov_b32 v14, s41
    ds_add_rtn_u32 v15, v144, v14 offset:24
    s_lshl_b32 s41, s39, 2
    s_lshl_b32 s10, s41, s51
    s_mov_b32 s11, 0
    s_waitcnt lgkmcnt(0)
    v_readfirstlane_b32 s38, v15
    s_cmp_ge_u32 s38, 0x10000
    s_cbranch_scc1 L_cxM0
    s_atomic_add_x2 s[10:11], s[44:45], 0x80 glc
    s_add_u32 s64, s40, s38
    s_lshl_b32 s38, s38, 8
    s_or_b32 s46, s38, s39
L_cxM0:
    s_mov_b64 exec, -1
    s_branch L_claimretM0
L_pubC0:
    s_mov_b64 s[38:39], s[10:11]
    s_and_b32 s40, s46, 0xff
    s_lshr_b32 s41, s46, 8
    s_bfm_b64 exec, s40, 0
    v_lshlrev_b32 v14, s51, v1
    v_lshl_add_u32 v16, v1, 3, s41
    v_lshl_add_u32 v14, v14, 2, s38
    v_mov_b32 v15, s39
    s_bfe_u32 s41, s38, 0xa000c
    s_lshr_b32 s38, s38, 22
    s_add_u32 s38, s38, s41
    ds_write_b64 v16, v[14:15] offset:8448
    s_lshl_b32 s41, s38, 1
    s_sub_u32 s41, s41, s64
    s_mov_b64 exec, 1
    v_mov_b32 v17, s41
    s_lshl2_add_u32 s38, s40, s38
    s_mov_b32 s46, 0
    ds_write_b32 v144, v17 offset:28
    s_cmp_lt_u32 s38, 512
    s_cbranch_scc1 L_pubxC0
    v_mov_b32 v18, 0x10008
    ds_add_rtn_u32 v19, v144, v18 offset:24
    v_bfrev_b32 v14, 1
    s_waitcnt lgkmcnt(0)
    v_and_b32 v19, 0xffff, v19
    ds_write_b64 v19, v[14:15] offset:8448
L_pubxC0:
    s_mov_b64 exec, -1
    s_branch L_pubretC0
L_waitC0:
L_waitlC0:
    s_add_u32 s3, s3, 1
    s_cmp_gt_u32 s3, 10000000
    s_cbranch_scc1 L_endp
    ds_read_b64 v[72:73], v71 offset:8448
    s_waitcnt lgkmcnt(0)
    v_readfirstlane_b32 s56, v72
    s_nop 3
    s_cmp_lg_u32 s56, 0
    s_cbranch_scc1 L_waitretC0
    s_branch L_waitlC0
L_claimC0:
    s_and_b32 s37, s37, -8
    s_cmp_lg_u32 s57, 0
    s_cbranch_scc1 L_goC0
    s_call_b64 s[40:41], L_check
L_goC0:
    ds_read_b64 v[14:15], v144 offset:24
    s_mul_i32 s40, s37, 3
    s_add_u32 s41, s37, 16
    s_waitcnt lgkmcnt(0)
    v_readfirstlane_b32 s38, v14
    v_readfirstlane_b32 s39, v15
    s_sub_u32 s41, s41, s38
    s_cmp_le_i32 s41, 0
    s_cbranch_scc1 L_claimretC0
    s_add_u32 s39, s39, s38
    s_add_u32 s39, s39, s40
    s_sub_u32 s39, 1024, s39
    s_mul_i32 s39, s39, 6
    s_ashr_i32 s39, s39, 8
    s_min_i32 s39, s39, 2
    s_lshr_b32 s41, s41, 3
    s_max_i32 s39, s39, s41
    s_lshl_b32 s41, s39, 3
    s_mov_b64 exec, 1
    v_mov_b32 v14, s41
    ds_add_rtn_u32 v15, v144, v14 offset:24
    s_lshl_b32 s41, s39, 2
    s_lshl_b32 s10, s41, s51
    s_mov_b32 s11, 0
    s_waitcnt lgkmcnt(0)
    v_readfirstlane_b32 s38, v15
    s_cmp_ge_u32 s38, 0x10000
    s_cbranch_scc1 L_cxC0
    s_atomic_add_x2 s[10:11], s[44:45], 0x80 glc
    s_add_u32 s64, s40, s38
    s_lshl_b32 s38, s38, 8
    s_or_b32 s46, s38, s39
L_cxC0:
    s_mov_b64 exec, -1
    s_branch L_claimretC0
L_sw0:
    buffer_load_dwordx4 v[76:79], v3, s[28:31], s14 offen offset:0 nt
    buffer_load_dwordx4 v[80:83], v146, s[28:31], s14 offen offset:0 nt
    buffer_load_dwordx4 v[84:87], v226, s[28:31], s14 offen offset:0 nt
    buffer_load_dwordx4 v[88:91], v227, s[28:31], s14 offen offset:0 nt
    s_mov_b32 s52, s14
    s_and_b32 s4, s37, -8
    s_sub_u32 s5, 768, s4
    s_sub_u32 s6, s4, 8
    v_mov_b32 v230, 8336
    v_and_b32 v14, 31, v1
    v_bfi_b32 v231, v9, 0, s4
    v_lshl_add_u32 v231, v14, 3, v231
    s_lshl_b32 s38, s33, 9
    s_or_b32 s66, s38, 1
    s_xor_b32 s54, s14, 0x8000
    s_branch L_claimretA0
L_mv0:
    v_readfirstlane_b32 s7, v73
    s_cmp_ge_u32 s37, 768
    s_cbranch_scc1 L_g3M0
    s_bfe_u32 s38, s56, s51
    s_and_b32 s40, s37, 6
    s_add_u32 s38, s38, s40
    s_and_b32 s59, s38, 0x4
    s_lshl_b32 s59, s59, 8
    s_xor_b32 s52, s59, s58
    s_and_b32 s59, s38, 0x12
    s_lshl_b32 s59, s59, 10
    s_xor_b32 s52, s59, s52
    s_and_b32 s59, s38, 0x1e0
    s_lshl_b32 s59, s59, 12
    s_xor_b32 s52, s59, s52
    s_and_b32 s59, s38, 0x8
    s_lshl_b32 s59, s59, 13
    s_xor_b32 s52, s59, s52
    s_and_b32 s59, s38, 0x601
    s_lshl_b32 s59, s59, 15
    s_xor_b32 s52, s59, s52
    s_lshl2_add_u32 s41, s40, 1
    s_lshl_b32 s38, s37, 8
    buffer_load_dwordx4 v[76:79], v3, s[28:31], s52 offen offset:0 nt
    buffer_load_dwordx4 v[80:83], v146, s[28:31], s52 offen offset:0 nt
    buffer_load_dwordx4 v[84:87], v226, s[28:31], s52 offen offset:0 nt
    buffer_load_dwordx4 v[88:91], v227, s[28:31], s52 offen offset:0 nt
    s_bitcmp1_b32 s7, s41
    s_cselect_b32 s39, 1, 3
    s_or_b32 s66, s38, s39
    s_xor_b32 s54, s52, 0x8000
    s_cmp_ge_u32 s37, s6
    s_cbranch_scc1 L_trigM0
    s_branch L_claimretM0
L_yv0:
    buffer_load_dwordx4 v[108:111], v3, s[28:31], s54 offen offset:0 nt
    buffer_load_dwordx4 v[112:115], v146, s[28:31], s54 offen offset:0 nt
    buffer_load_dwordx4 v[116:119], v226, s[28:31], s54 offen offset:0 nt
    buffer_load_dwordx4 v[120:123], v227, s[28:31], s54 offen offset:0 nt
    s_branch L_yvret0
L_odd0:
    s_bitcmp1_b32 s38, 2
    s_cbranch_scc1 L3_0
    s_xor_b32 s38, s52, 0x8000
    v_readfirstlane_b32 s37, v232
    buffer_load_dwordx4 v[188:191], v68, s[24:27], s52 offen offset:0 nt
    buffer_load_dwordx4 v[192:195], v69, s[24:27], s52 offen offset:0 nt
    buffer_load_dwordx4 v[196:199], v224, s[24:27], s52 offen offset:0 nt
    buffer_load_dwordx4 v[200:203], v225, s[24:27], s52 offen offset:0 nt
    buffer_load_dwordx4 v[204:207], v68, s[24:27], s38 offen offset:0 nt
    buffer_load_dwordx4 v[208:211], v69, s[24:27], s38 offen offset:0 nt
    buffer_load_dwordx4 v[212:215], v224, s[24:27], s38 offen offset:0 nt
    buffer_load_dwordx4 v[216:219], v225, s[24:27], s38 offen offset:0 nt
    s_waitcnt vmcnt(0)
    v_mfma_f32_16x16x32_bf16 v[52:55], v[188:191], v[48:51], 0
    v_mfma_f32_16x16x32_bf16 v[56:59], v[192:195], v[48:51], 0
    v_mfma_f32_16x16x32_bf16 v[60:63], v[196:199], v[48:51], 0
    v_mfma_f32_16x16x32_bf16 v[64:67], v[200:203], v[48:51], 0
    s_nop 7
    s_nop 3
    v_mov_b32_dpp v16, v52 quad_perm:[0,0,0,0] row_mask:0xf bank_mask:0xf
    v_mov_b32_dpp v17, v56 quad_perm:[0,0,0,0] row_mask:0xf bank_mask:0xf
    v_mov_b32_dpp v18, v60 quad_perm:[0,0,0,0] row_mask:0xf bank_mask:0xf
    v_mov_b32_dpp v19, v64 quad_perm:[0,0,0,0] row_mask:0xf bank_mask:0xf
    v_add_f32_dpp v16, v53, v16 quad_perm:[1,1,1,1] row_mask:0xf bank_mask:0xf
    v_add_f32_dpp v17, v57, v17 quad_perm:[1,1,1,1] row_mask:0xf bank_mask:0xf
    v_add_f32_dpp v18, v61, v18 quad_perm:[1,1,1,1] row_mask:0xf bank_mask:0xf
    v_add_f32_dpp v19, v65, v19 quad_perm:[1,1,1,1] row_mask:0xf bank_mask:0xf
    v_add_f32_dpp v16, v54, v16 quad_perm:[2,2,2,2] row_mask:0xf bank_mask:0xf
    v_add_f32_dpp v17, v58, v17 quad_perm:[2,2,2,2] row_mask:0xf bank_mask:0xf
    v_add_f32_dpp v18, v62, v18 quad_perm:[2,2,2,2] row_mask:0xf bank_mask:0xf
    v_add_f32_dpp v19, v66, v19 quad_perm:[2,2,2,2] row_mask:0xf bank_mask:0xf
    v_add_f32_dpp v16, v55, v16 quad_perm:[3,3,3,3] row_mask:0xf bank_mask:0xf
    v_add_f32_dpp v17, v59, v17 quad_perm:[3,3,3,3] row_mask:0xf bank_mask:0xf
    v_add_f32_dpp v18, v63, v18 quad_perm:[3,3,3,3] row_mask:0xf bank_mask:0xf
    v_add_f32_dpp v19, v67, v19 quad_perm:[3,3,3,3] row_mask:0xf bank_mask:0xf
    v_mfma_f32_16x16x32_bf16 v[52:55], v[204:207], v[48:51], 0
    v_mfma_f32_16x16x32_bf16 v[56:59], v[208:211], v[48:51], 0
    v_mfma_f32_16x16x32_bf16 v[60:63], v[212:215], v[48:51], 0
    v_mfma_f32_16x16x32_bf16 v[64:67], v[216:219], v[48:51], 0
    s_nop 7
    s_nop 3
    v_mov_b32_dpp v156, v52 quad_perm:[0,0,0,0] row_mask:0xf bank_mask:0xf
    v_mov_b32_dpp v157, v56 quad_perm:[0,0,0,0] row_mask:0xf bank_mask:0xf
    v_mov_b32_dpp v158, v60 quad_perm:[0,0,0,0] row_mask:0xf bank_mask:0xf
    v_mov_b32_dpp v159, v64 quad_perm:[0,0,0,0] row_mask:0xf bank_mask:0xf
    v_add_f32_dpp v156, v53, v156 quad_perm:[1,1,1,1] row_mask:0xf bank_mask:0xf
    v_add_f32_dpp v157, v57, v157 quad_perm:[1,1,1,1] row_mask:0xf bank_mask:0xf
    v_add_f32_dpp v158, v61, v158 quad_perm:[1,1,1,1] row_mask:0xf bank_mask:0xf
    v_add_f32_dpp v159, v65, v159 quad_perm:[1,1,1,1] row_mask:0xf bank_mask:0xf
    v_add_f32_dpp v156, v54, v156 quad_perm:[2,2,2,2] row_mask:0xf bank_mask:0xf
    v_add_f32_dpp v157, v58, v157 quad_perm:[2,2,2,2] row_mask:0xf bank_mask:0xf
    v_add_f32_dpp v158, v62, v158 quad_perm:[2,2,2,2] row_mask:0xf bank_mask:0xf
    v_add_f32_dpp v159, v66, v159 quad_perm:[2,2,2,2] row_mask:0xf bank_mask:0xf
    v_add_f32_dpp v156, v55, v156 quad_perm:[3,3,3,3] row_mask:0xf bank_mask:0xf
    v_add_f32_dpp v157, v59, v157 quad_perm:[3,3,3,3] row_mask:0xf bank_mask:0xf
    v_add_f32_dpp v158, v63, v158 quad_perm:[3,3,3,3] row_mask:0xf bank_mask:0xf
    v_add_f32_dpp v159, v67, v159 quad_perm:[3,3,3,3] row_mask:0xf bank_mask:0xf
    s_branch L_missret0
L_pubA1:
    s_mov_b64 s[38:39], s[10:11]
    s_and_b32 s40, s47, 0xff
    s_lshr_b32 s41, s47, 8
    s_bfm_b64 exec, s40, 0
    v_lshlrev_b32 v14, s51, v1
    v_lshl_add_u32 v16, v1, 3, s41
    v_lshl_add_u32 v14, v14, 2, s38
    v_mov_b32 v15, s39
    s_bfe_u32 s41, s38, 0xa000c
    s_lshr_b32 s38, s38, 22
    s_add_u32 s38, s38, s41
    ds_write_b64 v16, v[14:15] offset:8448
    s_lshl_b32 s41, s38, 1
    s_sub_u32 s41, s41, s65
    s_mov_b64 exec, 1
    v_mov_b32 v17, s41
    s_lshl2_add_u32 s38, s40, s38
    s_mov_b32 s47, 0
    ds_write_b32 v144, v17 offset:28
    s_cmp_lt_u32 s38, 512
    s_cbranch_scc1 L_pubxA1
    v_mov_b32 v18, 0x10008
    ds_add_rtn_u32 v19, v144, v18 offset:24
    v_bfrev_b32 v14, 1
    s_waitcnt lgkmcnt(0)
    v_and_b32 v19, 0xffff, v19
    ds_write_b64 v19, v[14:15] offset:8448
L_pubxA1:
    s_mov_b64 exec, -1
    s_branch L_pubretA1
L_waitA1:
L_waitlA1:
    s_add_u32 s3, s3, 1
    s_cmp_gt_u32 s3, 10000000
    s_cbranch_scc1 L_endp
    ds_read_b64 v[72:73], v71 offset:8448
    s_waitcnt lgkmcnt(0)
    v_readfirstlane_b32 s56, v72
    s_nop 3
    s_cmp_lg_u32 s56, 0
    s_cbranch_scc1 L_waitretA1
    s_branch L_waitlA1
L_claimA1:
    s_branch L_claimretA1
L_pubB1:
    s_mov_b64 s[38:39], s[10:11]
    s_and_b32 s40, s47, 0xff
    s_lshr_b32 s41, s47, 8
    s_bfm_b64 exec, s40, 0
    v_lshlrev_b32 v14, s51, v1
    v_lshl_add_u32 v16, v1, 3, s41
    v_lshl_add_u32 v14, v14, 2, s38
    v_mov_b32 v15, s39
    s_bfe_u32 s41, s38, 0xa000c
    s_lshr_b32 s38, s38, 22
    s_add_u32 s38, s38, s41
    ds_write_b64 v16, v[14:15] offset:8448
    s_lshl_b32 s41, s38, 1
    s_sub_u32 s41, s41, s65
    s_mov_b64 exec, 1
    v_mov_b32 v17, s41
    s_lshl2_add_u32 s38, s40, s38
    s_mov_b32 s47, 0
    ds_write_b32 v144, v17 offset:28
    s_cmp_lt_u32 s38, 512
    s_cbranch_scc1 L_pubxB1
    v_mov_b32 v18, 0x10008
    ds_add_rtn_u32 v19, v144, v18 offset:24
    v_bfrev_b32 v14, 1
    s_waitcnt lgkmcnt(0)
    v_and_b32 v19, 0xffff, v19
    ds_write_b64 v19, v[14:15] offset:8448
L_pubxB1:
    s_mov_b64 exec, -1
    s_branch L_pubretB1
L_waitB1:
L_waitlB1:
    s_add_u32 s3, s3, 1
    s_cmp_gt_u32 s3, 10000000
    s_cbranch_scc1 L_endp
    ds_read_b64 v[72:73], v71 offset:8448
    s_waitcnt lgkmcnt(0)
    v_readfirstlane_b32 s56, v72
    s_nop 3
    s_cmp_lg_u32 s56, 0
    s_cbranch_scc1 L_waitretB1
    s_branch L_waitlB1
L_g3B1:
    s_mov_b32 s67, 5
    s_cmp_eq_u32 s56, 0
    s_cbranch_scc1 L_waitB1
L_waitretB1:
    s_bfe_u32 s38, s56, s51
    s_bfe_u32 s39, s56, s22
    s_add_u32 s39, s39, s38
    s_bfe_u32 s40, s37, 0x20001
    s_add_u32 s38, s38, s40
    s_cmp_lt_u32 s39, 512
    s_cselect_b32 s49, s38, s39
    s_cselect_b32 s60, 1, 0
    s_cselect_b32 s40, s40, 2
    s_and_b32 s59, s49, 0x4
    s_lshl_b32 s59, s59, 8
    s_xor_b32 s53, s59, s13
    s_and_b32 s59, s49, 0x12
    s_lshl_b32 s59, s59, 10
    s_xor_b32 s53, s59, s53
    s_and_b32 s59, s49, 0x1e0
    s_lshl_b32 s59, s59, 12
    s_xor_b32 s53, s59, s53
    s_and_b32 s59, s49, 0x8
    s_lshl_b32 s59, s59, 13
    s_xor_b32 s53, s59, s53
    s_and_b32 s59, s49, 0x601
    s_lshl_b32 s59, s59, 15
    s_xor_b32 s53, s59, s53
    s_cmp_eq_u32 s40, 3
    buffer_load_dwordx4 v[92:95], v68, s[24:27], s53 offen offset:0 nt
    buffer_load_dwordx4 v[96:99], v69, s[24:27], s53 offen offset:0 nt
    buffer_load_dwordx4 v[100:103], v224, s[24:27], s53 offen offset:0 nt
    buffer_load_dwordx4 v[104:107], v225, s[24:27], s53 offen offset:0 nt
    s_mov_b32 s54, s53
    s_cbranch_scc1 L_claimB1
    s_branch L_claimretB1
L_trigB1:
    s_cmp_lg_u32 s40, 6
    s_cbranch_scc1 L_claimretB1
    s_add_u32 s37, s37, s5
L_claimB1:
    s_and_b32 s37, s37, -8
    s_cmp_lg_u32 s57, 0
    s_cbranch_scc1 L_goB1
    s_call_b64 s[40:41], L_check
L_goB1:
    ds_read_b64 v[14:15], v144 offset:24
    s_mul_i32 s40, s37, 3
    s_add_u32 s41, s37, 16
    s_waitcnt lgkmcnt(0)
    v_readfirstlane_b32 s38, v14
    v_readfirstlane_b32 s39, v15
    s_sub_u32 s41, s41, s38
    s_cmp_le_i32 s41, 0
    s_cbranch_scc1 L_claimretB1
    s_add_u32 s39, s39, s38
    s_add_u32 s39, s39, s40
    s_sub_u32 s39, 1024, s39
    s_mul_i32 s39, s39, 6
    s_ashr_i32 s39, s39, 8
    s_min_i32 s39, s39, 2
    s_lshr_b32 s41, s41, 3
    s_max_i32 s39, s39, s41
    s_lshl_b32 s41, s39, 3
    s_mov_b64 exec, 1
    v_mov_b32 v14, s41
    ds_add_rtn_u32 v15, v144, v14 offset:24
    s_lshl_b32 s41, s39, 2
    s_lshl_b32 s10, s41, s51
    s_mov_b32 s11, 0
    s_waitcnt lgkmcnt(0)
    v_readfirstlane_b32 s38, v15
    s_cmp_ge_u32 s38, 0x10000
    s_cbranch_scc1 L_cxB1
    s_atomic_add_x2 s[10:11], s[44:45], 0x80 glc
    s_add_u32 s65, s40, s38
    s_lshl_b32 s38, s38, 8
    s_or_b32 s47, s38, s39
L_cxB1:
    s_mov_b64 exec, -1
    s_branch L_claimretB1
L_waitM1:
L_waitlM1:
    s_add_u32 s3, s3, 1
    s_cmp_gt_u32 s3, 10000000
    s_cbranch_scc1 L_endp
    ds_read_b64 v[72:73], v71 offset:8448
    s_waitcnt lgkmcnt(0)
    v_readfirstlane_b32 s56, v72
    s_nop 3
    s_cmp_lg_u32 s56, 0
    s_cbranch_scc1 L_waitretM1
    s_branch L_waitlM1
L_g3M1:
    s_mov_b32 s67, 5
    s_cmp_eq_u32 s56, 0
    s_cbranch_scc1 L_waitM1
L_waitretM1:
    s_bfe_u32 s38, s56, s51
    s_bfe_u32 s39, s56, s22
    s_add_u32 s39, s39, s38
    s_bfe_u32 s40, s37, 0x20001
    s_add_u32 s38, s38, s40
    s_cmp_lt_u32 s39, 512
    s_cselect_b32 s49, s38, s39
    s_cselect_b32 s60, 1, 0
    s_cselect_b32 s40, s40, 2
    s_and_b32 s59, s49, 0x4
    s_lshl_b32 s59, s59, 8
    s_xor_b32 s53, s59, s13
    s_and_b32 s59, s49, 0x12
    s_lshl_b32 s59, s59, 10
    s_xor_b32 s53, s59, s53
    s_and_b32 s59, s49, 0x1e0
    s_lshl_b32 s59, s59, 12
    s_xor_b32 s53, s59, s53
    s_and_b32 s59, s49, 0x8
    s_lshl_b32 s59, s59, 13
    s_xor_b32 s53, s59, s53
    s_and_b32 s59, s49, 0x601
    s_lshl_b32 s59, s59, 15
    s_xor_b32 s53, s59, s53
    s_cmp_eq_u32 s40, 3
    buffer_load_dwordx4 v[92:95], v68, s[24:27], s53 offen offset:0 nt
    buffer_load_dwordx4 v[96:99], v69, s[24:27], s53 offen offset:0 nt
    buffer_load_dwordx4 v[100:103], v224, s[24:27], s53 offen offset:0 nt
    buffer_load_dwordx4 v[104:107], v225, s[24:27], s53 offen offset:0 nt
    s_mov_b32 s54, s53
    s_cbranch_scc1 L_claimM1
    s_branch L_claimretM1
L_trigM1:
    s_cmp_lg_u32 s40, 6
    s_cbranch_scc1 L_claimretM1
    s_add_u32 s37, s37, s5
L_claimM1:
    s_and_b32 s37, s37, -8
    s_cmp_lg_u32 s57, 0
    s_cbranch_scc1 L_goM1
    s_call_b64 s[40:41], L_check
L_goM1:
    ds_read_b64 v[14:15], v144 offset:24
    s_mul_i32 s40, s37, 3
    s_add_u32 s41, s37, 16
    s_waitcnt lgkmcnt(0)
    v_readfirstlane_b32 s38, v14
    v_readfirstlane_b32 s39, v15
    s_sub_u32 s41, s41, s38
    s_cmp_le_i32 s41, 0
    s_cbranch_scc1 L_claimretM1
    s_add_u32 s39, s39, s38
    s_add_u32 s39, s39, s40
    s_sub_u32 s39, 1024, s39
    s_mul_i32 s39, s39, 6
    s_ashr_i32 s39, s39, 8
    s_min_i32 s39, s39, 2
    s_lshr_b32 s41, s41, 3
    s_max_i32 s39, s39, s41
    s_lshl_b32 s41, s39, 3
    s_mov_b64 exec, 1
    v_mov_b32 v14, s41
    ds_add_rtn_u32 v15, v144, v14 offset:24
    s_lshl_b32 s41, s39, 2
    s_lshl_b32 s10, s41, s51
    s_mov_b32 s11, 0
    s_waitcnt lgkmcnt(0)
    v_readfirstlane_b32 s38, v15
    s_cmp_ge_u32 s38, 0x10000
    s_cbranch_scc1 L_cxM1
    s_atomic_add_x2 s[10:11], s[44:45], 0x80 glc
    s_add_u32 s65, s40, s38
    s_lshl_b32 s38, s38, 8
    s_or_b32 s47, s38, s39
L_cxM1:
    s_mov_b64 exec, -1
    s_branch L_claimretM1
L_pubC1:
    s_mov_b64 s[38:39], s[10:11]
    s_and_b32 s40, s47, 0xff
    s_lshr_b32 s41, s47, 8
    s_bfm_b64 exec, s40, 0
    v_lshlrev_b32 v14, s51, v1
    v_lshl_add_u32 v16, v1, 3, s41
    v_lshl_add_u32 v14, v14, 2, s38
    v_mov_b32 v15, s39
    s_bfe_u32 s41, s38, 0xa000c
    s_lshr_b32 s38, s38, 22
    s_add_u32 s38, s38, s41
    ds_write_b64 v16, v[14:15] offset:8448
    s_lshl_b32 s41, s38, 1
    s_sub_u32 s41, s41, s65
    s_mov_b64 exec, 1
    v_mov_b32 v17, s41
    s_lshl2_add_u32 s38, s40, s38
    s_mov_b32 s47, 0
    ds_write_b32 v144, v17 offset:28
    s_cmp_lt_u32 s38, 512
    s_cbranch_scc1 L_pubxC1
    v_mov_b32 v18, 0x10008
    ds_add_rtn_u32 v19, v144, v18 offset:24
    v_bfrev_b32 v14, 1
    s_waitcnt lgkmcnt(0)
    v_and_b32 v19, 0xffff, v19
    ds_write_b64 v19, v[14:15] offset:8448
L_pubxC1:
    s_mov_b64 exec, -1
    s_branch L_pubretC1
L_waitC1:
L_waitlC1:
    s_add_u32 s3, s3, 1
    s_cmp_gt_u32 s3, 10000000
    s_cbranch_scc1 L_endp
    ds_read_b64 v[72:73], v71 offset:8448
    s_waitcnt lgkmcnt(0)
    v_readfirstlane_b32 s56, v72
    s_nop 3
    s_cmp_lg_u32 s56, 0
    s_cbranch_scc1 L_waitretC1
    s_branch L_waitlC1
L_claimC1:
    s_and_b32 s37, s37, -8
    s_cmp_lg_u32 s57, 0
    s_cbranch_scc1 L_goC1
    s_call_b64 s[40:41], L_check
L_goC1:
    ds_read_b64 v[14:15], v144 offset:24
    s_mul_i32 s40, s37, 3
    s_add_u32 s41, s37, 16
    s_waitcnt lgkmcnt(0)
    v_readfirstlane_b32 s38, v14
    v_readfirstlane_b32 s39, v15
    s_sub_u32 s41, s41, s38
    s_cmp_le_i32 s41, 0
    s_cbranch_scc1 L_claimretC1
    s_add_u32 s39, s39, s38
    s_add_u32 s39, s39, s40
    s_sub_u32 s39, 1024, s39
    s_mul_i32 s39, s39, 6
    s_ashr_i32 s39, s39, 8
    s_min_i32 s39, s39, 2
    s_lshr_b32 s41, s41, 3
    s_max_i32 s39, s39, s41
    s_lshl_b32 s41, s39, 3
    s_mov_b64 exec, 1
    v_mov_b32 v14, s41
    ds_add_rtn_u32 v15, v144, v14 offset:24
    s_lshl_b32 s41, s39, 2
    s_lshl_b32 s10, s41, s51
    s_mov_b32 s11, 0
    s_waitcnt lgkmcnt(0)
    v_readfirstlane_b32 s38, v15
    s_cmp_ge_u32 s38, 0x10000
    s_cbranch_scc1 L_cxC1
    s_atomic_add_x2 s[10:11], s[44:45], 0x80 glc
    s_add_u32 s65, s40, s38
    s_lshl_b32 s38, s38, 8
    s_or_b32 s47, s38, s39
L_cxC1:
    s_mov_b64 exec, -1
    s_branch L_claimretC1
L_sw1:
    buffer_load_dwordx4 v[92:95], v3, s[28:31], s14 offen offset:0 nt
    buffer_load_dwordx4 v[96:99], v146, s[28:31], s14 offen offset:0 nt
    buffer_load_dwordx4 v[100:103], v226, s[28:31], s14 offen offset:0 nt
    buffer_load_dwordx4 v[104:107], v227, s[28:31], s14 offen offset:0 nt
    s_mov_b32 s53, s14
    s_and_b32 s4, s37, -8
    s_sub_u32 s5, 768, s4
    s_sub_u32 s6, s4, 8
    v_mov_b32 v230, 8336
    v_and_b32 v14, 31, v1
    v_bfi_b32 v231, v9, 0, s4
    v_lshl_add_u32 v231, v14, 3, v231
    s_lshl_b32 s38, s33, 9
    s_or_b32 s67, s38, 1
    s_xor_b32 s54, s14, 0x8000
    s_branch L_claimretA1
L_mv1:
    v_readfirstlane_b32 s7, v73
    s_cmp_ge_u32 s37, 768
    s_cbranch_scc1 L_g3M1
    s_bfe_u32 s38, s56, s51
    s_and_b32 s40, s37, 6
    s_add_u32 s38, s38, s40
    s_and_b32 s59, s38, 0x4
    s_lshl_b32 s59, s59, 8
    s_xor_b32 s53, s59, s58
    s_and_b32 s59, s38, 0x12
    s_lshl_b32 s59, s59, 10
    s_xor_b32 s53, s59, s53
    s_and_b32 s59, s38, 0x1e0
    s_lshl_b32 s59, s59, 12
    s_xor_b32 s53, s59, s53
    s_and_b32 s59, s38, 0x8
    s_lshl_b32 s59, s59, 13
    s_xor_b32 s53, s59, s53
    s_and_b32 s59, s38, 0x601
    s_lshl_b32 s59, s59, 15
    s_xor_b32 s53, s59, s53
    s_lshl2_add_u32 s41, s40, 1
    s_lshl_b32 s38, s37, 8
    buffer_load_dwordx4 v[92:95], v3, s[28:31], s53 offen offset:0 nt
    buffer_load_dwordx4 v[96:99], v146, s[28:31], s53 offen offset:0 nt
    buffer_load_dwordx4 v[100:103], v226, s[28:31], s53 offen offset:0 nt
    buffer_load_dwordx4 v[104:107], v227, s[28:31], s53 offen offset:0 nt
    s_bitcmp1_b32 s7, s41
    s_cselect_b32 s39, 1, 3
    s_or_b32 s67, s38, s39
    s_xor_b32 s54, s53, 0x8000
    s_cmp_ge_u32 s37, s6
    s_cbranch_scc1 L_trigM1
    s_branch L_claimretM1
L_yv1:
    buffer_load_dwordx4 v[124:127], v3, s[28:31], s54 offen offset:0 nt
    buffer_load_dwordx4 v[128:131], v146, s[28:31], s54 offen offset:0 nt
    buffer_load_dwordx4 v[132:135], v226, s[28:31], s54 offen offset:0 nt
    buffer_load_dwordx4 v[136:139], v227, s[28:31], s54 offen offset:0 nt
    s_branch L_yvret1
L_odd1:
    s_bitcmp1_b32 s38, 2
    s_cbranch_scc1 L3_1
    s_xor_b32 s38, s53, 0x8000
    v_readfirstlane_b32 s37, v232
    buffer_load_dwordx4 v[188:191], v68, s[24:27], s53 offen offset:0 nt
    buffer_load_dwordx4 v[192:195], v69, s[24:27], s53 offen offset:0 nt
    buffer_load_dwordx4 v[196:199], v224, s[24:27], s53 offen offset:0 nt
    buffer_load_dwordx4 v[200:203], v225, s[24:27], s53 offen offset:0 nt
    buffer_load_dwordx4 v[204:207], v68, s[24:27], s38 offen offset:0 nt
    buffer_load_dwordx4 v[208:211], v69, s[24:27], s38 offen offset:0 nt
    buffer_load_dwordx4 v[212:215], v224, s[24:27], s38 offen offset:0 nt
    buffer_load_dwordx4 v[216:219], v225, s[24:27], s38 offen offset:0 nt
    s_waitcnt vmcnt(0)
    v_mfma_f32_16x16x32_bf16 v[52:55], v[188:191], v[48:51], 0
    v_mfma_f32_16x16x32_bf16 v[56:59], v[192:195], v[48:51], 0
    v_mfma_f32_16x16x32_bf16 v[60:63], v[196:199], v[48:51], 0
    v_mfma_f32_16x16x32_bf16 v[64:67], v[200:203], v[48:51], 0
    s_nop 7
    s_nop 3
    v_mov_b32_dpp v16, v52 quad_perm:[0,0,0,0] row_mask:0xf bank_mask:0xf
    v_mov_b32_dpp v17, v56 quad_perm:[0,0,0,0] row_mask:0xf bank_mask:0xf
    v_mov_b32_dpp v18, v60 quad_perm:[0,0,0,0] row_mask:0xf bank_mask:0xf
    v_mov_b32_dpp v19, v64 quad_perm:[0,0,0,0] row_mask:0xf bank_mask:0xf
    v_add_f32_dpp v16, v53, v16 quad_perm:[1,1,1,1] row_mask:0xf bank_mask:0xf
    v_add_f32_dpp v17, v57, v17 quad_perm:[1,1,1,1] row_mask:0xf bank_mask:0xf
    v_add_f32_dpp v18, v61, v18 quad_perm:[1,1,1,1] row_mask:0xf bank_mask:0xf
    v_add_f32_dpp v19, v65, v19 quad_perm:[1,1,1,1] row_mask:0xf bank_mask:0xf
    v_add_f32_dpp v16, v54, v16 quad_perm:[2,2,2,2] row_mask:0xf bank_mask:0xf
    v_add_f32_dpp v17, v58, v17 quad_perm:[2,2,2,2] row_mask:0xf bank_mask:0xf
    v_add_f32_dpp v18, v62, v18 quad_perm:[2,2,2,2] row_mask:0xf bank_mask:0xf
    v_add_f32_dpp v19, v66, v19 quad_perm:[2,2,2,2] row_mask:0xf bank_mask:0xf
    v_add_f32_dpp v16, v55, v16 quad_perm:[3,3,3,3] row_mask:0xf bank_mask:0xf
    v_add_f32_dpp v17, v59, v17 quad_perm:[3,3,3,3] row_mask:0xf bank_mask:0xf
    v_add_f32_dpp v18, v63, v18 quad_perm:[3,3,3,3] row_mask:0xf bank_mask:0xf
    v_add_f32_dpp v19, v67, v19 quad_perm:[3,3,3,3] row_mask:0xf bank_mask:0xf
    v_mfma_f32_16x16x32_bf16 v[52:55], v[204:207], v[48:51], 0
    v_mfma_f32_16x16x32_bf16 v[56:59], v[208:211], v[48:51], 0
    v_mfma_f32_16x16x32_bf16 v[60:63], v[212:215], v[48:51], 0
    v_mfma_f32_16x16x32_bf16 v[64:67], v[216:219], v[48:51], 0
    s_nop 7
    s_nop 3
    v_mov_b32_dpp v156, v52 quad_perm:[0,0,0,0] row_mask:0xf bank_mask:0xf
    v_mov_b32_dpp v157, v56 quad_perm:[0,0,0,0] row_mask:0xf bank_mask:0xf
    v_mov_b32_dpp v158, v60 quad_perm:[0,0,0,0] row_mask:0xf bank_mask:0xf
    v_mov_b32_dpp v159, v64 quad_perm:[0,0,0,0] row_mask:0xf bank_mask:0xf
    v_add_f32_dpp v156, v53, v156 quad_perm:[1,1,1,1] row_mask:0xf bank_mask:0xf
    v_add_f32_dpp v157, v57, v157 quad_perm:[1,1,1,1] row_mask:0xf bank_mask:0xf
    v_add_f32_dpp v158, v61, v158 quad_perm:[1,1,1,1] row_mask:0xf bank_mask:0xf
    v_add_f32_dpp v159, v65, v159 quad_perm:[1,1,1,1] row_mask:0xf bank_mask:0xf
    v_add_f32_dpp v156, v54, v156 quad_perm:[2,2,2,2] row_mask:0xf bank_mask:0xf
    v_add_f32_dpp v157, v58, v157 quad_perm:[2,2,2,2] row_mask:0xf bank_mask:0xf
    v_add_f32_dpp v158, v62, v158 quad_perm:[2,2,2,2] row_mask:0xf bank_mask:0xf
    v_add_f32_dpp v159, v66, v159 quad_perm:[2,2,2,2] row_mask:0xf bank_mask:0xf
    v_add_f32_dpp v156, v55, v156 quad_perm:[3,3,3,3] row_mask:0xf bank_mask:0xf
    v_add_f32_dpp v157, v59, v157 quad_perm:[3,3,3,3] row_mask:0xf bank_mask:0xf
    v_add_f32_dpp v158, v63, v158 quad_perm:[3,3,3,3] row_mask:0xf bank_mask:0xf
    v_add_f32_dpp v159, v67, v159 quad_perm:[3,3,3,3] row_mask:0xf bank_mask:0xf
    s_branch L_missret1
L_check:
    s_mov_b32 s59, 0
L_poll:
    s_add_u32 s3, s3, 50
    s_cmp_gt_u32 s3, 10000000
    s_cbranch_scc1 L_endp
    global_load_dword v16, v75, s[18:19] offset:4 sc1
    s_waitcnt vmcnt(0)
    v_readfirstlane_b32 s57, v16
    s_add_u32 s59, s59, 1
    s_nop 3
    s_cmp_lg_u32 s57, 0
    s_cbranch_scc1 L_pollret
    s_sleep 4
    s_cmp_lg_u32 s59, 16
    s_cbranch_scc1 L_poll
    s_call_b64 s[42:43], L_elect
    s_branch L_poll
L_pollret:
    s_setpc_b64 s[40:41]
L_elect:
    v_mov_b32 v15, 1
    v_mov_b32 v14, 0x304000
    s_mov_b64 exec, 1
    global_atomic_add v16, v75, v15, s[18:19] sc0 sc1
    global_atomic_add v17, v14, v15, s[20:21] sc0 sc1
    s_waitcnt vmcnt(0)
    v_readfirstlane_b32 s38, v16
    v_readfirstlane_b32 s39, v17
    s_mov_b64 exec, -1
    s_nop 2
    s_cmp_lg_u32 s38, 0
    s_cbranch_scc1 L_elret
    v_lshlrev_b32 v14, 8, v1
    v_add_u32 v14, 0x300000, v14
    s_xor_b32 s39, s39, 0x80000000
    v_mov_b32 v17, s39
    v_mov_b32 v18, 0x340f0000
    v_mov_b32 v19, s39
    global_atomic_swap_x2 v[18:19], v14, v[18:19], s[20:21] offset:128 sc0 sc1
    s_waitcnt vmcnt(0)
    s_mov_b64 exec, 1
    global_atomic_add v75, v15, s[18:19] offset:4 sc1
    s_mov_b64 exec, -1
L_elret:
    s_setpc_b64 s[42:43]
L_stubX0:
    s_call_b64 s[42:43], L_rare16
    s_branch L_backX0
L_stubY0:
    s_call_b64 s[42:43], L_rare156
    s_branch L_backY0
L_stubX1:
    s_call_b64 s[42:43], L_rare16
    s_branch L_backX1
L_stubY1:
    s_call_b64 s[42:43], L_rare156
    s_branch L_backY1
L_stubZ0:
    s_call_b64 s[42:43], L_rare16
    s_branch L_backZ0
L_stubZ1:
    s_call_b64 s[42:43], L_rare16
    s_branch L_backZ1
L_rare16:
    v_max3_f32 v4, v16, v17, v18
    v_max_f32 v4, v4, v19
    v_mul_f32 v4, s32, v4
    v_mov_b32 v14, v4
    s_nop 1
    v_permlane32_swap_b32 v14, v4
    v_max_f32 v4, v4, v14
    v_mov_b32 v14, v4
    s_nop 1
    v_permlane16_swap_b32 v14, v4
    v_max3_f32 v4, v4, v14, v6
    v_sub_f32 v14, v6, v4
    v_exp_f32 v14, v14
    v_mov_b32 v6, v4
    v_mul_f32 v7, v7, v14
    ds_bpermute_b32 v15, v8, v14
    v_fma_f32 v20, v16, s32, -v6
    v_fma_f32 v21, v17, s32, -v6
    v_fma_f32 v22, v18, s32, -v6
    v_fma_f32 v23, v19, s32, -v6
    s_waitcnt lgkmcnt(0)
    v_mul_f32 v40, v15, v40
    v_mul_f32 v41, v15, v41
    v_mul_f32 v42, v15, v42
    v_mul_f32 v43, v15, v43
    v_mul_f32 v44, v15, v44
    v_mul_f32 v45, v15, v45
    v_mul_f32 v46, v15, v46
    v_mul_f32 v47, v15, v47
    s_setpc_b64 s[42:43]
L_rare156:
    v_max3_f32 v4, v156, v157, v158
    v_max_f32 v4, v4, v159
    v_mul_f32 v4, s32, v4
    v_mov_b32 v14, v4
    s_nop 1
    v_permlane32_swap_b32 v14, v4
    v_max_f32 v4, v4, v14
    v_mov_b32 v14, v4
    s_nop 1
    v_permlane16_swap_b32 v14, v4
    v_max3_f32 v4, v4, v14, v6
    v_sub_f32 v14, v6, v4
    v_exp_f32 v14, v14
    v_mov_b32 v6, v4
    v_mul_f32 v7, v7, v14
    ds_bpermute_b32 v15, v8, v14
    v_fma_f32 v20, v156, s32, -v6
    v_fma_f32 v21, v157, s32, -v6
    v_fma_f32 v22, v158, s32, -v6
    v_fma_f32 v23, v159, s32, -v6
    s_waitcnt lgkmcnt(0)
    v_mul_f32 v40, v15, v40
    v_mul_f32 v41, v15, v41
    v_mul_f32 v42, v15, v42
    v_mul_f32 v43, v15, v43
    v_mul_f32 v44, v15, v44
    v_mul_f32 v45, v15, v45
    v_mul_f32 v46, v15, v46
    v_mul_f32 v47, v15, v47
    s_setpc_b64 s[42:43]
.section .rodata,"a"
.p2align 6
.amdhsa_kernel standalone__tree_speculative_verify_tree_attention_over_candidate_token_tree__sampling_kernel
  .amdhsa_next_free_vgpr 236
  .amdhsa_next_free_sgpr 72
  .amdhsa_accum_offset 236
  .amdhsa_group_segment_fixed_size 0
  .amdhsa_kernarg_size 72
  .amdhsa_user_sgpr_count 2
  .amdhsa_user_sgpr_kernarg_segment_ptr 1
  .amdhsa_system_sgpr_workgroup_id_x 1
.end_amdhsa_kernel
```
